```python
import torch

def _softmax(x, axis=-1):
    return torch.softmax(x, dim=axis)
def _gelu(x):
    return torch.nn.functional.gelu(x, approximate="tanh")
def _silu(x):
    return torch.nn.functional.silu(x)
def _sigmoid(x):
    return torch.sigmoid(x)
def _layernorm(x, axis=-1, eps=1e-5):
    m = x.mean(dim=axis, keepdim=True)
    v = x.var(dim=axis, keepdim=True, unbiased=False)
    return (x - m) / torch.sqrt(v + eps)
def _scatter_add(tgt, idx, src, axis=0):
    return tgt.clone().index_add_(axis, idx, src)
def _segment_sum(src, seg, n):
    out = torch.zeros((n,) + src.shape[1:], dtype=src.dtype)
    return out.index_add_(0, seg, src)
def _pad(x, pw):
    flat = tuple(v for pair in reversed(pw) for v in pair)
    return torch.nn.functional.pad(x, flat)

kernel_name = 'gated_mix__ssm_conv_s5__glu_gated_swiglu__prompt'

def setup_inputs():

    _w = (lambda a: (lambda t: t.to(torch.bfloat16) if t.is_floating_point() else t)(torch.as_tensor(a)))
    def _A_setup():
        B, S, D = 1, 2048, 448
        P = D
        Lambda_re = -0.5 * (lambda _x: torch.exp(torch.as_tensor(_x)))((lambda *s: torch.randn(*s, dtype=torch.bfloat16) * 0.2)(P))
        Lambda_im = (lambda *s: torch.randn(*s, dtype=torch.bfloat16) * 0.4)(P) * 1.0
        B_re = (lambda *s: torch.randn(*s, dtype=torch.bfloat16) * 0.2)(P, D) * (D ** -0.5)
        B_im = (lambda *s: torch.randn(*s, dtype=torch.bfloat16) * 0.2)(P, D) * (D ** -0.5)
        C_re = (lambda *s: torch.randn(*s, dtype=torch.bfloat16) * 0.2)(D, P) * (P ** -0.5)
        C_im = (lambda *s: torch.randn(*s, dtype=torch.bfloat16) * 0.2)(D, P) * (P ** -0.5)
        log_dt = (lambda *s: torch.randn(*s, dtype=torch.bfloat16) * 0.2)(P) * 0.3 - 2.0
        Dskip = (lambda *s: torch.randn(*s, dtype=torch.bfloat16) * 0.05)(D)
        return {
            "x": _w((lambda *s: torch.randn(*s, dtype=torch.bfloat16) * 0.05)(B, S, D)),
            "Lambda_re": _w(Lambda_re),
            "Lambda_im": _w(Lambda_im),
            "B_re": _w(B_re),
            "B_im": _w(B_im),
            "C_re": _w(C_re),
            "C_im": _w(C_im),
            "log_dt": _w(log_dt),
            "Dskip": _w(Dskip),
        }
    _A_in = _A_setup()

    def _B_setup():
        B, S, D, F = 1, 2048, 448, 1792
        return {
            "x": _w((lambda *s: torch.randn(*s, dtype=torch.bfloat16) * 0.05)(B, S, D)),
            "w1": _w((lambda *s: torch.randn(*s, dtype=torch.bfloat16) * 0.8)(D, F) * (2.0 / D) ** 0.5),
            "w3": _w((lambda *s: torch.randn(*s, dtype=torch.bfloat16) * 0.8)(D, F) * (2.0 / D) ** 0.5),
            "w2": _w((lambda *s: torch.randn(*s, dtype=torch.bfloat16) * 0.8)(F, D) * (2.0 / F) ** 0.5),
        }
    _B_in = _B_setup()

    return {
        "A_x": _A_in["x"],
        "A_Lambda_re": _A_in["Lambda_re"],
        "A_Lambda_im": _A_in["Lambda_im"],
        "A_B_re": _A_in["B_re"],
        "A_B_im": _A_in["B_im"],
        "A_C_re": _A_in["C_re"],
        "A_C_im": _A_in["C_im"],
        "A_log_dt": _A_in["log_dt"],
        "A_Dskip": _A_in["Dskip"],
        "B_x": _B_in["x"],
        "B_w1": _B_in["w1"],
        "B_w3": _B_in["w3"],
        "B_w2": _B_in["w2"],
        "gate_w": _w((lambda *s: torch.randn(*s, dtype=torch.bfloat16) * 0.05)(448) * 16.0),
    }

def reference(A_x, A_Lambda_re, A_Lambda_im, A_B_re, A_B_im, A_C_re, A_C_im, A_log_dt, A_Dskip, B_x, B_w1, B_w3, B_w2, gate_w):
    def _A_ref(x, Lambda_re, Lambda_im, B_re, B_im, C_re, C_im, log_dt, Dskip):
        Bsz, L, H = x.shape
        Lam = Lambda_re + 1j * Lambda_im
        Bmat = B_re + 1j * B_im
        Cmat = C_re + 1j * C_im
        dt = torch.exp(log_dt)
        Lam_bar = torch.exp(dt * Lam)
        B_bar = ((Lam_bar - 1.0) / Lam)[:, None] * Bmat
        Bu = torch.einsum("bld,pd->blp", x + 0j, B_bar)
        h = torch.zeros_like(Bu[:, 0, :])
        hs = []
        for t in range(L):
            h = Lam_bar[None, :] * h + Bu[:, t, :]
            hs.append(h)
        hseq = torch.stack(hs, 1)
        y = 2.0 * torch.einsum("blp,dp->bld", hseq, Cmat).real + x * Dskip[None, None, :]
        return y

    def _B_ref(x, w1, w3, w2):
        gate = torch.einsum("bsd,df->bsf", x, w1)
        up = torch.einsum("bsd,df->bsf", x, w3)
        h = _silu(gate) * up
        out = torch.einsum("bsf,fd->bsd", h, w2)
        return out

    x = A_x
    g = _sigmoid((x * gate_w).sum(-1, keepdims=True))
    a = _A_ref(x, A_Lambda_re, A_Lambda_im, A_B_re, A_B_im, A_C_re, A_C_im, A_log_dt, A_Dskip)
    b = _B_ref(x, B_w1, B_w3, B_w2)
    return g * a + (1 - g) * b
```

```asm
; @launch grid=(256,1,1) block=(256,1,1) lds=163840
.amdgcn_target "amdgcn-amd-amdhsa--gfx950"
.text
.globl gated_mix__ssm_conv_s5__glu_gated_swiglu__prompt_kernel
.p2align 8
.type gated_mix__ssm_conv_s5__glu_gated_swiglu__prompt_kernel,@function
gated_mix__ssm_conv_s5__glu_gated_swiglu__prompt_kernel:
    s_load_dwordx16 s[16:31], s[0:1], 0
    s_load_dwordx16 s[32:47], s[0:1], 64
    s_load_dwordx2 s[48:49], s[0:1], 128
    s_getpc_b64 s[4:5]
PCBASE:
    s_cmp_ge_u32 s2, 0x100
    s_cbranch_scc1 L_END
    v_lshrrev_b32 v8, 6, v0
    v_and_b32 v1, 63, v0
    v_readfirstlane_b32 s3, v8
    v_lshlrev_b32 v2, 4, v1
    s_mov_b32 s51, 0
    s_mul_i32 s82, s3, 0xa000
    s_cmp_lt_u32 s2, 32
    s_cbranch_scc1 L_HELPER
    s_sub_u32 s6, s2, 32
    s_and_b32 s7, s6, 7
    s_lshr_b32 s8, s6, 3
    s_mul_i32 s9, s7, 28
    s_add_u32 s9, s9, s8
    s_lshr_b32 s81, s9, 5
    s_and_b32 s80, s9, 31
    s_lshr_b32 s84, s3, 1
    s_and_b32 s85, s3, 1
    s_add_u32 s10, s80, s81
    s_mul_i32 s11, s10, 37
    s_lshr_b32 s11, s11, 8
    s_mul_i32 s11, s11, 7
    s_sub_u32 s14, s10, s11
    s_lshl_b32 s14, s14, 7
    v_lshrrev_b32 v8, 4, v1
    v_and_b32 v9, 7, v1
    v_xor_b32 v8, v8, v9
    v_lshlrev_b32 v11, 4, v8
    v_bfe_u32 v9, v1, 3, 2
    v_lshrrev_b32 v10, 5, v1
    v_lshl_add_u32 v9, v10, 4, v9
    s_lshl_b32 s9, s80, 6
    s_lshl_b32 s10, s84, 5
    s_add_u32 s15, s9, s10
    s_lshl_b32 s10, s85, 3
    s_add_u32 s9, s15, s10
    v_add_u32 v9, s9, v9
    v_mul_u32_u24 v9, 0x380, v9
    v_add_u32 v20, v9, v11
    v_xor_b32 v10, 64, v20
    v_add_u32 v21, 0xa00, v10
    s_lshl_b32 s10, s85, 5
    v_lshrrev_b32 v12, 3, v1
    v_add_u32 v9, s10, v12
    v_mul_u32_u24 v9, 0x380, v9
    v_add_u32 v22, v9, v11
    v_xor_b32 v10, 64, v22
    v_add_u32 v23, 0x1800, v10
    v_add_u32 v24, 0x3000, v22
    v_add_u32 v25, 0x4800, v10
    s_mul_i32 s11, s81, 0xe000
    s_waitcnt lgkmcnt(0)
    s_mov_b32 s52, s16
    s_mov_b32 s53, s17
    s_mov_b32 s54, 0x1c0000
    s_mov_b32 s55, 0x20000
    s_cmp_ge_u32 s3, 2
    s_cselect_b32 s56, s24, s22
    s_cselect_b32 s57, s25, s23
    s_mov_b32 s58, 0xe000
    s_mov_b32 s59, 0x20000
    s_add_u32 s56, s56, s11
    s_addc_u32 s57, s57, 0
    s_mov_b32 s22, s14
    s_add_u32 m0, s82, 0x6000
    s_nop 0
    buffer_load_dwordx4 v20, s[52:55], s22 offen lds
    buffer_load_dwordx4 v21, s[52:55], s22 offen offset:1024 lds
    s_add_u32 m0, s82, 0
    s_nop 0
    buffer_load_dwordx4 v22, s[56:59], s22 offen lds
    buffer_load_dwordx4 v23, s[56:59], s22 offen offset:1024 lds
    buffer_load_dwordx4 v24, s[56:59], s22 offen offset:2048 lds
    buffer_load_dwordx4 v25, s[56:59], s22 offen offset:3072 lds
    s_add_u32 s23, s22, 0x80
    s_cmp_eq_u32 s23, 0x380
    s_cselect_b32 s23, 0, s23
    s_add_u32 m0, s82, 0x6800
    s_nop 0
    buffer_load_dwordx4 v20, s[52:55], s23 offen lds
    buffer_load_dwordx4 v21, s[52:55], s23 offen offset:1024 lds
    s_add_u32 m0, s82, 0x1000
    s_nop 0
    buffer_load_dwordx4 v22, s[56:59], s23 offen lds
    buffer_load_dwordx4 v23, s[56:59], s23 offen offset:1024 lds
    buffer_load_dwordx4 v24, s[56:59], s23 offen offset:2048 lds
    buffer_load_dwordx4 v25, s[56:59], s23 offen offset:3072 lds
    s_lshl_b32 s9, s81, 6
    s_lshl_b32 s10, s85, 5
    s_add_u32 s9, s9, s10
    v_and_b32 v8, 31, v1
    v_add_lshl_u32 v8, v8, s9, 1
    global_load_ushort v34, v8, s[18:19]
    global_load_ushort v35, v8, s[20:21]
    global_load_ushort v36, v8, s[30:31]
    s_mov_b32 s64, s48
    s_mov_b32 s65, s49
    s_mov_b32 s66, 0xf80000
    s_mov_b32 s67, 0x20000
    v_mov_b32 v37, 0xf08000
    buffer_load_dword v37, v37, s[64:67], 0 offen
    s_bfe_u32 s6, s2, 0x30003
    s_lshl_b32 s6, s6, 12
    v_lshl_add_u32 v9, v0, 4, s6
    global_load_dwordx4 v[4:7], v9, s[4:5]
    s_cmp_ge_u32 s3, 2
    s_cselect_b32 s60, s38, s36
    s_cselect_b32 s61, s39, s37
    s_mov_b32 s62, 0x188000
    s_mov_b32 s63, 0x20000
    s_cmp_ge_u32 s3, 2
    s_cselect_b32 s68, s28, s26
    s_cselect_b32 s69, s29, s27
    s_mov_b32 s70, 0x62000
    s_mov_b32 s71, 0x20000
    s_lshl_b32 s9, s81, 7
    s_add_u32 s68, s68, s9
    s_addc_u32 s69, s69, 0
    s_sub_u32 s70, s70, s9
    s_mov_b32 s88, s40
    s_mov_b32 s89, s41
    s_mov_b32 s90, 0x38000
    s_mov_b32 s91, 0x20000
    s_mul_i32 s9, s81, 0x38000
    s_add_u32 s88, s88, s9
    s_addc_u32 s89, s89, 0
    s_mov_b32 s72, s44
    s_mov_b32 s73, s45
    s_mov_b32 s74, 0x380000
    s_mov_b32 s75, 0x20000
    s_lshr_b32 s9, s80, 0
    s_mov_b32 s9, 0
    s_add_u32 s10, s9, 0
    s_and_b32 s10, s10, 3
    s_lshl_b32 s42, s10, 7
    s_add_u32 s10, s9, 1
    s_and_b32 s10, s10, 3
    s_lshl_b32 s43, s10, 7
    s_add_u32 s10, s9, 2
    s_and_b32 s10, s10, 3
    s_lshl_b32 s46, s10, 7
    s_add_u32 s10, s9, 3
    s_and_b32 s10, s10, 3
    s_lshl_b32 s47, s10, 7
    s_add_u32 s9, s9, s84
    s_add_u32 s10, s9, 0
    s_and_b32 s10, s10, 3
    s_mul_i32 s40, s10, 0xe000
    s_add_u32 s10, s9, 2
    s_and_b32 s10, s10, 3
    s_mul_i32 s41, s10, 0xe000
    s_add_u32 s24, s23, 0x80
    s_cmp_eq_u32 s24, 0x380
    s_cselect_b32 s24, 0, s24
    s_add_u32 s25, s24, 0x80
    s_cmp_eq_u32 s25, 0x380
    s_cselect_b32 s25, 0, s25
    s_add_u32 s34, s25, 0x80
    s_cmp_eq_u32 s34, 0x380
    s_cselect_b32 s34, 0, s34
    s_add_u32 s35, s34, 0x80
    s_cmp_eq_u32 s35, 0x380
    s_cselect_b32 s35, 0, s35
    s_add_u32 s36, s35, 0x80
    s_cmp_eq_u32 s36, 0x380
    s_cselect_b32 s36, 0, s36
    v_bfe_u32 v8, v1, 4, 1
    v_lshlrev_b32 v8, 2, v8
    v_and_b32 v9, 7, v1
    v_xor_b32 v8, v8, v9
    v_lshlrev_b32 v8, 4, v8
    s_lshl_b32 s10, s85, 5
    v_add_u32 v9, s10, v12
    v_mul_u32_u24 v9, 0xe00, v9
    s_lshl_b32 s10, s81, 9
    v_add3_u32 v26, v8, v9, s10
    v_add_u32 v27, 0x6c00, v26
    v_add_u32 v28, 0xd800, v26
    v_add_u32 v29, 0x14400, v26
    s_lshl_b32 s10, s85, 5
    v_add_u32 v9, s10, v12
    v_mul_u32_u24 v9, 0x380, v9
    v_add_u32 v30, v8, v9
    v_add_u32 v31, 0x1800, v30
    v_add_u32 v32, 0x3000, v30
    v_add_u32 v33, 0x4800, v30
    v_bfe_u32 v8, v1, 1, 3
    v_lshrrev_b32 v9, 5, v1
    v_xor_b32 v8, v8, v9
    v_lshlrev_b32 v8, 4, v8
    v_and_b32 v9, 15, v1
    v_lshl_add_u32 v10, v9, 7, v8
    v_bfe_u32 v9, v1, 4, 1
    v_mul_u32_u24 v9, 0xa000, v9
    s_mul_i32 s9, s84, 0x14000
    v_add3_u32 v38, v9, v10, s9
    v_and_b32 v9, 31, v1
    v_lshl_add_u32 v10, v9, 7, v8
    s_mul_i32 s9, s85, 0xa000
    v_add_u32 v42, s9, v10
    v_xor_b32 v39, 32, v38
    v_xor_b32 v43, 32, v42
    v_xor_b32 v40, 64, v38
    v_xor_b32 v44, 64, v42
    v_xor_b32 v41, 0x60, v38
    v_xor_b32 v45, 0x60, v42
    v_add_u32 v46, 0x14000, v42
    v_add_u32 v47, 0x14000, v43
    v_add_u32 v48, 0x14000, v44
    v_add_u32 v49, 0x14000, v45
    v_bfe_u32 v8, v1, 3, 1
    v_xor_b32 v8, s85, v8
    v_lshlrev_b32 v8, 6, v8
    v_bfe_u32 v9, v1, 4, 1
    v_lshl_add_u32 v8, v9, 5, v8
    v_and_b32 v9, 3, v1
    v_lshl_add_u32 v8, v9, 3, v8
    v_bfe_u32 v9, v1, 2, 2
    v_lshl_add_u32 v8, v9, 7, v8
    v_lshrrev_b32 v9, 5, v1
    v_lshl_add_u32 v50, v9, 10, v8
    v_add_u32 v51, 0xa000, v50
    v_add_u32 v52, 0x14000, v50
    v_add_u32 v53, 0x1e000, v50
    v_lshl_add_u32 v8, v9, 9, v8
    s_mul_i32 s9, s85, 0xa000
    s_sub_u32 s10, 0xa000, s9
    v_add_u32 v54, s9, v8
    v_add_u32 v55, s10, v8
    v_add_u32 v56, 0x14000, v54
    v_add_u32 v57, 0x14000, v55
    s_mov_b32 s101, 0
    s_waitcnt vmcnt(11)
    s_barrier
    ds_read_b128 a[0:3], v38 offset:24576
    ds_read_b128 v[156:159], v42
    ds_read_b128 v[160:163], v46
    ds_read_b128 a[4:7], v39 offset:24576
    ds_read_b128 v[164:167], v43
    ds_read_b128 v[168:171], v47
    ds_read_b128 a[8:11], v40 offset:24576
    ds_read_b128 v[172:175], v44
    s_waitcnt lgkmcnt(5)
    v_mfma_f32_32x32x16_bf16 v[60:75], a[0:3], v[156:159], 0
    ds_read_b128 v[176:179], v48
    s_add_u32 m0, s82, 0x7000
    s_nop 0
    buffer_load_dwordx4 v20, s[52:55], s24 offen lds
    buffer_load_dwordx4 v21, s[52:55], s24 offen offset:1024 lds
    v_mfma_f32_32x32x16_bf16 v[76:91], a[0:3], v[160:163], 0
    ds_read_b128 a[12:15], v41 offset:24576
    ds_read_b128 v[180:183], v45
    s_add_u32 m0, s82, 0x2000
    s_nop 0
    buffer_load_dwordx4 v22, s[56:59], s24 offen lds
    s_waitcnt lgkmcnt(5)
    v_mfma_f32_32x32x16_bf16 v[60:75], a[4:7], v[164:167], v[60:75]
    ds_read_b128 v[184:187], v49
    buffer_load_dwordx4 v23, s[56:59], s24 offen offset:1024 lds
    v_bfe_u32 v16, v1, 2, 1
    v_bfe_u32 v17, v1, 3, 2
    v_lshlrev_b32 v16, 4, v16
    s_waitcnt vmcnt(9)
    s_barrier
    v_mfma_f32_32x32x16_bf16 v[76:91], a[4:7], v[168:171], v[76:91]
    ds_read_b128 a[16:19], v38 offset:26624
    ds_read_b128 v[156:159], v42 offset:4096
    buffer_load_dwordx4 v24, s[56:59], s24 offen offset:2048 lds
    v_lshl_add_u32 v16, v17, 2, v16
    v_and_b32 v17, 3, v1
    v_add3_u32 v16, v16, v17, s15
    s_waitcnt lgkmcnt(5)
    v_mfma_f32_32x32x16_bf16 v[60:75], a[8:11], v[172:175], v[60:75]
    ds_read_b128 v[160:163], v46 offset:4096
    buffer_load_dwordx4 v25, s[56:59], s24 offen offset:3072 lds
    v_lshlrev_b32 v225, 3, v16
    v_add_u32 v225, 0xf00000, v225
    v_mfma_f32_32x32x16_bf16 v[76:91], a[8:11], v[176:179], v[76:91]
    ds_read_b128 a[20:23], v39 offset:26624
    ds_read_b128 v[164:167], v43 offset:4096
    s_add_u32 m0, s82, 0x7800
    s_nop 0
    buffer_load_dwordx4 v20, s[52:55], s25 offen lds
    buffer_load_dwordx4 v21, s[52:55], s25 offen offset:1024 lds
    v_lshrrev_b32 v16, 5, v1
    v_lshlrev_b32 v16, 4, v16
    v_and_or_b32 v226, v1, 15, v16
    s_waitcnt lgkmcnt(5)
    v_mfma_f32_32x32x16_bf16 v[60:75], a[12:15], v[180:183], v[60:75]
    ds_read_b128 v[168:171], v47 offset:4096
    s_add_u32 m0, s82, 0x3000
    s_nop 0
    buffer_load_dwordx4 v22, s[56:59], s25 offen lds
    v_add_lshl_u32 v226, v226, s15, 3
    v_add_u32 v226, 0xf00000, v226
    v_mfma_f32_32x32x16_bf16 v[76:91], a[12:15], v[184:187], v[76:91]
    ds_read_b128 a[24:27], v40 offset:26624
    ds_read_b128 v[172:175], v44 offset:4096
    buffer_load_dwordx4 v23, s[56:59], s25 offen offset:1024 lds
    s_lshl_b32 s6, s81, 6
    s_lshl_b32 s7, s85, 5
    s_add_u32 s6, s6, s7
    s_waitcnt lgkmcnt(5)
    v_mfma_f32_32x32x16_bf16 v[60:75], a[16:19], v[156:159], v[60:75]
    ds_read_b128 v[176:179], v48 offset:4096
    buffer_load_dwordx4 v24, s[56:59], s25 offen offset:2048 lds
    v_and_b32 v17, 31, v1
    v_add_u32 v18, s6, v17
    v_mfma_f32_32x32x16_bf16 v[76:91], a[16:19], v[160:163], v[76:91]
    ds_read_b128 a[28:31], v41 offset:26624
    ds_read_b128 v[180:183], v45 offset:4096
    buffer_load_dwordx4 v25, s[56:59], s25 offen offset:3072 lds
    v_add_u32 v16, s15, v16
    v_mul_u32_u24 v16, 0x1c0, v16
    v_add_u32 v16, v16, v18
    s_waitcnt lgkmcnt(5)
    v_mfma_f32_32x32x16_bf16 v[60:75], a[20:23], v[164:167], v[60:75]
    ds_read_b128 v[184:187], v49 offset:4096
    s_add_u32 m0, s82, 0x8000
    s_nop 0
    buffer_load_dwordx4 v20, s[52:55], s34 offen lds
    buffer_load_dwordx4 v21, s[52:55], s34 offen offset:1024 lds
    v_lshlrev_b32 v236, 2, v16
    v_lshlrev_b32 v237, 1, v16
    v_lshlrev_b32 v238, 1, v18
    s_waitcnt vmcnt(8)
    s_barrier
    v_mfma_f32_32x32x16_bf16 v[76:91], a[20:23], v[168:171], v[76:91]
    ds_read_b128 a[32:35], v38 offset:28672
    ds_read_b128 v[156:159], v42 offset:8192
    s_add_u32 m0, s82, 0x4000
    s_nop 0
    buffer_load_dwordx4 v22, s[56:59], s34 offen lds
    s_lshl_b32 s6, s81, 1
    s_add_u32 s6, s6, s85
    s_waitcnt lgkmcnt(5)
    v_mfma_f32_32x32x16_bf16 v[60:75], a[24:27], v[172:175], v[60:75]
    ds_read_b128 v[160:163], v46 offset:8192
    buffer_load_dwordx4 v23, s[56:59], s34 offen offset:1024 lds
    s_lshl_b32 s6, s6, 6
    s_lshr_b32 s7, s15, 5
    s_add_u32 s6, s6, s7
    v_mfma_f32_32x32x16_bf16 v[76:91], a[24:27], v[176:179], v[76:91]
    ds_read_b128 a[36:39], v39 offset:28672
    ds_read_b128 v[164:167], v43 offset:8192
    buffer_load_dwordx4 v24, s[56:59], s34 offen offset:2048 lds
    s_lshl_b32 s6, s6, 9
    s_add_u32 s6, s6, 0xe00000
    s_waitcnt lgkmcnt(5)
    v_mfma_f32_32x32x16_bf16 v[60:75], a[28:31], v[180:183], v[60:75]
    ds_read_b128 v[168:171], v47 offset:8192
    buffer_load_dwordx4 v25, s[56:59], s34 offen offset:3072 lds
    v_lshl_add_u32 v227, v17, 4, s6
    s_mul_i32 s6, s80, 0x70000
    s_lshl_b32 s7, s3, 11
    v_mfma_f32_32x32x16_bf16 v[76:91], a[28:31], v[184:187], v[76:91]
    ds_read_b128 a[40:43], v40 offset:28672
    ds_read_b128 v[172:175], v44 offset:8192
    s_add_u32 m0, s82, 0x8800
    s_nop 0
    buffer_load_dwordx4 v20, s[52:55], s35 offen lds
    buffer_load_dwordx4 v21, s[52:55], s35 offen offset:1024 lds
    s_add_u32 s6, s6, s7
    s_lshl_b32 s7, s81, 13
    s_waitcnt lgkmcnt(5)
    v_mfma_f32_32x32x16_bf16 v[60:75], a[32:35], v[156:159], v[60:75]
    ds_read_b128 v[176:179], v48 offset:8192
    s_add_u32 m0, s82, 0x5000
    s_nop 0
    buffer_load_dwordx4 v22, s[56:59], s35 offen lds
    s_add_u32 s7, s7, s6
    v_add_u32 v239, s7, v2
    s_lshl_b32 s7, s81, 16
    v_mfma_f32_32x32x16_bf16 v[76:91], a[32:35], v[160:163], v[76:91]
    ds_read_b128 a[44:47], v41 offset:28672
    ds_read_b128 v[180:183], v45 offset:8192
    buffer_load_dwordx4 v23, s[56:59], s35 offen offset:1024 lds
    s_add_u32 s7, s7, s6
    v_add_u32 v240, s7, v2
    s_waitcnt lgkmcnt(5)
    v_mfma_f32_32x32x16_bf16 v[60:75], a[36:39], v[164:167], v[60:75]
    ds_read_b128 v[184:187], v49 offset:8192
    s_mul_i32 s6, s80, 43
    s_lshr_b32 s6, s6, 8
    s_mul_i32 s6, s6, 6
    s_sub_u32 s6, s80, s6
    s_waitcnt vmcnt(10)
    s_barrier
    v_mfma_f32_32x32x16_bf16 v[76:91], a[36:39], v[168:171], v[76:91]
    ds_read_b128 a[48:51], v38 offset:30720
    ds_read_b128 v[156:159], v42 offset:12288
    buffer_load_dwordx4 v24, s[56:59], s35 offen offset:2048 lds
    s_lshl_b32 s6, s6, 7
    s_lshl_b32 s39, s81, 7
    s_add_u32 s7, s39, s6
    s_waitcnt lgkmcnt(5)
    v_mfma_f32_32x32x16_bf16 v[60:75], a[40:43], v[172:175], v[60:75]
    ds_read_b128 v[160:163], v46 offset:12288
    buffer_load_dwordx4 v25, s[56:59], s35 offen offset:3072 lds
    s_add_u32 s7, s7, 0x80
    s_sub_u32 s26, s7, 0x380
    s_min_u32 s26, s26, s7
    v_mfma_f32_32x32x16_bf16 v[76:91], a[40:43], v[176:179], v[76:91]
    ds_read_b128 a[52:55], v39 offset:30720
    ds_read_b128 v[164:167], v43 offset:12288
    s_add_u32 m0, s82, 0x9000
    s_nop 0
    buffer_load_dwordx4 v20, s[52:55], s36 offen lds
    buffer_load_dwordx4 v21, s[52:55], s36 offen offset:1024 lds
    s_sub_u32 s7, s39, s6
    s_add_u32 s7, s7, 0x300
    s_sub_u32 s93, s7, 0x380
    s_waitcnt lgkmcnt(5)
    v_mfma_f32_32x32x16_bf16 v[60:75], a[44:47], v[180:183], v[60:75]
    ds_read_b128 v[168:171], v47 offset:12288
    s_add_u32 m0, s82, 0
    s_nop 0
    buffer_load_dwordx4 v22, s[56:59], s36 offen lds
    s_min_u32 s93, s93, s7
    s_add_u32 s6, s6, 0x80
    s_sub_u32 s7, s6, 0x300
    v_mfma_f32_32x32x16_bf16 v[76:91], a[44:47], v[184:187], v[76:91]
    ds_read_b128 a[56:59], v40 offset:30720
    ds_read_b128 v[172:175], v44 offset:12288
    buffer_load_dwordx4 v23, s[56:59], s36 offen offset:1024 lds
    s_min_u32 s6, s6, s7
    s_add_u32 s7, s39, s6
    s_add_u32 s7, s7, 0x80
    s_waitcnt lgkmcnt(5)
    v_mfma_f32_32x32x16_bf16 v[60:75], a[48:51], v[156:159], v[60:75]
    ds_read_b128 v[176:179], v48 offset:12288
    buffer_load_dwordx4 v24, s[56:59], s36 offen offset:2048 lds
    s_sub_u32 s27, s7, 0x380
    s_min_u32 s27, s27, s7
    s_sub_u32 s7, s39, s6
    v_mfma_f32_32x32x16_bf16 v[76:91], a[48:51], v[160:163], v[76:91]
    ds_read_b128 a[60:63], v41 offset:30720
    ds_read_b128 v[180:183], v45 offset:12288
    buffer_load_dwordx4 v25, s[56:59], s36 offen offset:3072 lds
    s_add_u32 s7, s7, 0x300
    s_sub_u32 s94, s7, 0x380
    s_min_u32 s94, s94, s7
    s_add_u32 s6, s6, 0x80
    s_waitcnt lgkmcnt(5)
    v_mfma_f32_32x32x16_bf16 v[60:75], a[52:55], v[164:167], v[60:75]
    ds_read_b128 v[184:187], v49 offset:12288
    s_sub_u32 s7, s6, 0x300
    s_min_u32 s6, s6, s7
    s_add_u32 s7, s39, s6
    v_lshlrev_b32 v34, 16, v34
    v_lshlrev_b32 v35, 16, v35
    s_waitcnt vmcnt(12)
    s_barrier
    v_mfma_f32_32x32x16_bf16 v[76:91], a[52:55], v[168:171], v[76:91]
    ds_read_b128 a[64:67], v38 offset:32768
    ds_read_b128 v[156:159], v42 offset:16384
    s_add_u32 m0, s82, 0x1000
    s_mul_i32 s98, s22, 0x700
    s_add_u32 s98, s98, s42
    buffer_load_dwordx4 v26, s[60:63], s98 offen lds
    s_add_u32 s7, s7, 0x80
    s_sub_u32 s28, s7, 0x380
    s_min_u32 s28, s28, s7
    v_lshlrev_b32 v36, 16, v36
    v_mul_f32 v36, 0x3fb8aa3b, v36
    s_waitcnt lgkmcnt(5)
    v_mfma_f32_32x32x16_bf16 v[60:75], a[56:59], v[172:175], v[60:75]
    ds_read_b128 v[160:163], v46 offset:16384
    buffer_load_dwordx4 v27, s[60:63], s98 offen offset:1024 lds
    s_sub_u32 s7, s39, s6
    s_add_u32 s7, s7, 0x300
    s_sub_u32 s95, s7, 0x380
    v_exp_f32 v36, v36
    v_mfma_f32_32x32x16_bf16 v[76:91], a[56:59], v[176:179], v[76:91]
    ds_read_b128 a[68:71], v39 offset:32768
    ds_read_b128 v[164:167], v43 offset:16384
    buffer_load_dwordx4 v28, s[60:63], s98 offen offset:2048 lds
    s_min_u32 s95, s95, s7
    s_add_u32 s6, s6, 0x80
    s_sub_u32 s7, s6, 0x300
    v_cvt_pk_bf16_f32 v36, 0, v36
    v_mul_f32 v12, v36, v34
    s_waitcnt lgkmcnt(5)
    v_mfma_f32_32x32x16_bf16 v[60:75], a[60:63], v[180:183], v[60:75]
    ds_read_b128 v[168:171], v47 offset:16384
    buffer_load_dwordx4 v29, s[60:63], s98 offen offset:3072 lds
    s_min_u32 s6, s6, s7
    s_add_u32 s7, s39, s6
    s_add_u32 s7, s7, 0x80
    v_mul_f32 v13, v36, v35
    v_mul_f32 v12, 0x3fb8aa3b, v12
    v_mfma_f32_32x32x16_bf16 v[76:91], a[60:63], v[184:187], v[76:91]
    ds_read_b128 a[72:75], v40 offset:32768
    ds_read_b128 v[172:175], v44 offset:16384
    s_add_u32 m0, s82, 0x6000
    s_mul_i32 s98, s23, 0x700
    s_add_u32 s98, s98, s42
    buffer_load_dwordx4 v26, s[60:63], s98 offen lds
    s_sub_u32 s29, s7, 0x380
    s_min_u32 s29, s29, s7
    s_sub_u32 s7, s39, s6
    v_exp_f32 v12, v12
    s_waitcnt lgkmcnt(5)
    v_mfma_f32_32x32x16_bf16 v[60:75], a[64:67], v[156:159], v[60:75]
    ds_read_b128 v[176:179], v48 offset:16384
    s_add_u32 s7, s7, 0x300
    s_sub_u32 s96, s7, 0x380
    s_min_u32 s96, s96, s7
    s_add_u32 s6, s6, 0x80
    v_mul_f32 v13, 0x3e22f983, v13
    v_rndne_f32 v14, v13
    v_mfma_f32_32x32x16_bf16 v[76:91], a[64:67], v[160:163], v[76:91]
    ds_read_b128 a[76:79], v41 offset:32768
    ds_read_b128 v[180:183], v45 offset:16384
    buffer_load_dwordx4 v27, s[60:63], s98 offen offset:1024 lds
    s_sub_u32 s7, s6, 0x300
    s_min_u32 s6, s6, s7
    s_add_u32 s7, s39, s6
    v_sub_f32 v13, v13, v14
    v_cos_f32 v14, v13
    s_waitcnt lgkmcnt(5)
    v_mfma_f32_32x32x16_bf16 v[60:75], a[68:71], v[164:167], v[60:75]
    ds_read_b128 v[184:187], v49 offset:16384
    s_add_u32 s7, s7, 0x80
    s_sub_u32 s37, s7, 0x380
    s_min_u32 s37, s37, s7
    v_sin_f32 v15, v13
    s_waitcnt vmcnt(12)
    s_barrier
    v_mfma_f32_32x32x16_bf16 v[76:91], a[68:71], v[168:171], v[76:91]
    ds_read_b128 a[80:83], v38 offset:34816
    ds_read_b128 v[156:159], v42 offset:20480
    buffer_load_dwordx4 v28, s[60:63], s98 offen offset:2048 lds
    s_sub_u32 s7, s39, s6
    s_add_u32 s7, s7, 0x300
    s_sub_u32 s97, s7, 0x380
    v_mul_f32 v14, v12, v14
    s_waitcnt lgkmcnt(5)
    v_mfma_f32_32x32x16_bf16 v[60:75], a[72:75], v[172:175], v[60:75]
    ds_read_b128 v[160:163], v46 offset:20480
    buffer_load_dwordx4 v29, s[60:63], s98 offen offset:3072 lds
    s_min_u32 s97, s97, s7
    s_add_u32 s6, s6, 0x80
    s_sub_u32 s7, s6, 0x300
    v_mul_f32 v15, v12, v15
    v_add_f32 v12, -1.0, v14
    v_mfma_f32_32x32x16_bf16 v[76:91], a[72:75], v[176:179], v[76:91]
    ds_read_b128 a[84:87], v39 offset:34816
    ds_read_b128 v[164:167], v43 offset:20480
    s_add_u32 m0, s82, 0x2000
    s_mul_i32 s98, s24, 0x700
    s_add_u32 s98, s98, s42
    buffer_load_dwordx4 v26, s[60:63], s98 offen lds
    s_min_u32 s6, s6, s7
    s_add_u32 s7, s39, s6
    s_add_u32 s7, s7, 0x80
    v_mul_f32 v13, v34, v34
    v_fmac_f32 v13, v35, v35
    s_waitcnt lgkmcnt(5)
    v_mfma_f32_32x32x16_bf16 v[60:75], a[76:79], v[180:183], v[60:75]
    ds_read_b128 v[168:171], v47 offset:20480
    buffer_load_dwordx4 v27, s[60:63], s98 offen offset:1024 lds
    s_sub_u32 s38, s7, 0x380
    s_min_u32 s38, s38, s7
    s_sub_u32 s7, s39, s6
    v_rcp_f32 v13, v13
    v_mfma_f32_32x32x16_bf16 v[76:91], a[76:79], v[184:187], v[76:91]
    ds_read_b128 a[88:91], v40 offset:34816
    ds_read_b128 v[172:175], v44 offset:20480
    buffer_load_dwordx4 v28, s[60:63], s98 offen offset:2048 lds
    s_add_u32 s7, s7, 0x300
    s_sub_u32 s86, s7, 0x380
    s_min_u32 s86, s86, s7
    v_mul_f32 v58, v12, v34
    v_fmac_f32 v58, v15, v35
    s_waitcnt lgkmcnt(5)
    v_mfma_f32_32x32x16_bf16 v[60:75], a[80:83], v[156:159], v[60:75]
    ds_read_b128 v[176:179], v48 offset:20480
    buffer_load_dwordx4 v29, s[60:63], s98 offen offset:3072 lds
    v_mul_f32 v59, v15, v34
    v_fma_f32 v59, -v12, v35, v59
    v_mfma_f32_32x32x16_bf16 v[76:91], a[80:83], v[160:163], v[76:91]
    ds_read_b128 a[92:95], v41 offset:34816
    ds_read_b128 v[180:183], v45 offset:20480
    s_add_u32 m0, s82, 0x3000
    s_mul_i32 s98, s25, 0x700
    s_add_u32 s98, s98, s42
    buffer_load_dwordx4 v26, s[60:63], s98 offen lds
    v_add_f32 v13, v13, v13
    v_mul_f32 v58, v58, v13
    s_waitcnt lgkmcnt(5)
    v_mfma_f32_32x32x16_bf16 v[60:75], a[84:87], v[164:167], v[60:75]
    ds_read_b128 v[184:187], v49 offset:20480
    v_mul_f32 v59, v59, v13
    v_sub_f32 v220, 0, v15
    s_waitcnt vmcnt(13)
    s_barrier
    v_mfma_f32_32x32x16_bf16 v[76:91], a[84:87], v[168:171], v[76:91]
    ds_read_b128 a[96:99], v38 offset:36864
    ds_read_b128 v[156:159], v42
    buffer_load_dwordx4 v27, s[60:63], s98 offen offset:1024 lds
    v_mov_b32 v34, v14
    v_mov_b32 v35, v15
    s_waitcnt lgkmcnt(5)
    v_mfma_f32_32x32x16_bf16 v[60:75], a[88:91], v[172:175], v[60:75]
    ds_read_b128 v[160:163], v46
    buffer_load_dwordx4 v28, s[60:63], s98 offen offset:2048 lds
    v_mul_f32 v12, v35, v35
    v_mul_f32 v13, v34, v35
    v_mfma_f32_32x32x16_bf16 v[76:91], a[88:91], v[176:179], v[76:91]
    ds_read_b128 a[100:103], v39 offset:36864
    ds_read_b128 v[164:167], v43
    buffer_load_dwordx4 v29, s[60:63], s98 offen offset:3072 lds
    v_fma_f32 v221, v34, v34, -v12
    v_add_f32 v222, v13, v13
    s_waitcnt lgkmcnt(5)
    v_mfma_f32_32x32x16_bf16 v[60:75], a[92:95], v[180:183], v[60:75]
    ds_read_b128 v[168:171], v47
    v_mul_f32 v12, v222, v222
    v_mul_f32 v13, v221, v222
    v_mfma_f32_32x32x16_bf16 v[76:91], a[92:95], v[184:187], v[76:91]
    ds_read_b128 a[104:107], v40 offset:36864
    ds_read_b128 v[172:175], v44
    s_add_u32 m0, s82, 0x7000
    s_mul_i32 s98, s34, 0x700
    s_add_u32 s98, s98, s42
    buffer_load_dwordx4 v26, s[60:63], s98 offen lds
    v_fma_f32 v221, v221, v221, -v12
    v_add_f32 v222, v13, v13
    s_waitcnt lgkmcnt(5)
    v_mfma_f32_32x32x16_bf16 v[60:75], a[96:99], v[156:159], v[60:75]
    ds_read_b128 v[176:179], v48
    v_mul_f32 v12, v222, v222
    v_mul_f32 v13, v221, v222
    v_mfma_f32_32x32x16_bf16 v[76:91], a[96:99], v[160:163], v[76:91]
    ds_read_b128 a[108:111], v41 offset:36864
    ds_read_b128 v[180:183], v45
    buffer_load_dwordx4 v27, s[60:63], s98 offen offset:1024 lds
    v_fma_f32 v221, v221, v221, -v12
    v_add_f32 v222, v13, v13
    s_waitcnt lgkmcnt(5)
    v_mfma_f32_32x32x16_bf16 v[60:75], a[100:103], v[164:167], v[60:75]
    ds_read_b128 v[184:187], v49
    v_mul_f32 v12, v222, v222
    v_mul_f32 v13, v221, v222
    s_waitcnt vmcnt(14)
    s_barrier
    v_mfma_f32_32x32x16_bf16 v[76:91], a[100:103], v[168:171], v[76:91]
    ds_read_b64_tr_b16 v[156:157], v50 offset:4096
    ds_read_b64_tr_b16 v[158:159], v50 offset:4608
    buffer_load_dwordx4 v28, s[60:63], s98 offen offset:2048 lds
    v_fma_f32 v221, v221, v221, -v12
    v_add_f32 v222, v13, v13
    s_waitcnt lgkmcnt(5)
    v_mfma_f32_32x32x16_bf16 v[60:75], a[104:107], v[172:175], v[60:75]
    ds_read_b64_tr_b16 v[160:161], v52 offset:4096
    ds_read_b64_tr_b16 v[162:163], v52 offset:4608
    buffer_load_dwordx4 v29, s[60:63], s98 offen offset:3072 lds
    v_mfma_f32_32x32x16_bf16 v[76:91], a[104:107], v[176:179], v[76:91]
    ds_read_b64_tr_b16 v[164:165], v50 offset:6144
    ds_read_b64_tr_b16 v[166:167], v50 offset:6656
    s_add_u32 m0, s82, 0x4000
    s_mul_i32 s98, s35, 0x700
    s_add_u32 s98, s98, s42
    buffer_load_dwordx4 v26, s[60:63], s98 offen lds
    v_readfirstlane_b32 s50, v37
    s_nop 0
    s_lshr_b32 s83, s50, 3
    s_add_u32 s83, s83, 1
    s_lshl_b32 s83, s83, 3
    s_waitcnt lgkmcnt(6)
    v_mfma_f32_32x32x16_bf16 v[60:75], a[108:111], v[180:183], v[60:75]
    ds_read_b64_tr_b16 v[168:169], v52 offset:6144
    ds_read_b64_tr_b16 v[170:171], v52 offset:6656
    v_mfma_f32_32x32x16_bf16 v[76:91], a[108:111], v[184:187], v[76:91]
    ds_read_b64_tr_b16 v[172:173], v51 offset:4096
    ds_read_b64_tr_b16 v[174:175], v51 offset:4608
    buffer_load_dwordx4 v27, s[60:63], s98 offen offset:1024 lds
    s_waitcnt lgkmcnt(6)
    v_mfma_f32_32x32x16_bf16 v[92:107], v[156:159], a[0:3], 0
    ds_read_b64_tr_b16 v[176:177], v53 offset:4096
    ds_read_b64_tr_b16 v[178:179], v53 offset:4608
    v_mfma_f32_32x32x16_bf16 v[108:123], v[160:163], a[0:3], 0
    ds_read_b64_tr_b16 v[180:181], v51 offset:6144
    ds_read_b64_tr_b16 v[182:183], v51 offset:6656
    buffer_load_dwordx4 v28, s[60:63], s98 offen offset:2048 lds
    s_waitcnt lgkmcnt(6)
    v_mfma_f32_32x32x16_bf16 v[92:107], v[164:167], a[4:7], v[92:107]
    ds_read_b64_tr_b16 v[184:185], v53 offset:6144
    ds_read_b64_tr_b16 v[186:187], v53 offset:6656
    v_fma_f32 v12, v34, v60, v61
    v_fma_f32 v13, v34, v76, v77
    v_fmac_f32 v12, v220, v76
    s_waitcnt vmcnt(15)
    s_barrier
    v_mfma_f32_32x32x16_bf16 v[108:123], v[168:171], a[4:7], v[108:123]
    ds_read_b64_tr_b16 v[156:157], v50 offset:24576
    ds_read_b64_tr_b16 v[158:159], v50 offset:25088
    buffer_load_dwordx4 v29, s[60:63], s98 offen offset:3072 lds
    v_fmac_f32 v13, v35, v60
    v_fma_f32 v14, v34, v12, v62
    v_fma_f32 v15, v34, v13, v78
    s_waitcnt lgkmcnt(6)
    v_mfma_f32_32x32x16_bf16 v[92:107], v[172:175], a[8:11], v[92:107]
    ds_read_b64_tr_b16 v[160:161], v52 offset:24576
    ds_read_b64_tr_b16 v[162:163], v52 offset:25088
    v_fmac_f32 v14, v220, v13
    v_fmac_f32 v15, v35, v12
    v_fma_f32 v12, v34, v14, v63
    v_mfma_f32_32x32x16_bf16 v[108:123], v[176:179], a[8:11], v[108:123]
    ds_read_b64_tr_b16 v[164:165], v50 offset:26624
    ds_read_b64_tr_b16 v[166:167], v50 offset:27136
    s_add_u32 m0, s82, 0x5000
    s_mul_i32 s98, s36, 0x700
    s_add_u32 s98, s98, s42
    buffer_load_dwordx4 v26, s[60:63], s98 offen lds
    v_fma_f32 v13, v34, v15, v79
    v_fmac_f32 v12, v220, v15
    v_fmac_f32 v13, v35, v14
    s_waitcnt lgkmcnt(6)
    v_mfma_f32_32x32x16_bf16 v[92:107], v[180:183], a[12:15], v[92:107]
    ds_read_b64_tr_b16 v[168:169], v52 offset:26624
    ds_read_b64_tr_b16 v[170:171], v52 offset:27136
    v_fma_f32 v14, v34, v12, v64
    v_fma_f32 v15, v34, v13, v80
    v_fmac_f32 v14, v220, v13
    v_mfma_f32_32x32x16_bf16 v[108:123], v[184:187], a[12:15], v[108:123]
    ds_read_b64_tr_b16 v[172:173], v51 offset:24576
    ds_read_b64_tr_b16 v[174:175], v51 offset:25088
    buffer_load_dwordx4 v27, s[60:63], s98 offen offset:1024 lds
    v_fmac_f32 v15, v35, v12
    v_fma_f32 v12, v34, v14, v65
    v_fma_f32 v13, v34, v15, v81
    s_waitcnt lgkmcnt(6)
    v_mfma_f32_32x32x16_bf16 v[92:107], v[156:159], a[16:19], v[92:107]
    ds_read_b64_tr_b16 v[176:177], v53 offset:24576
    ds_read_b64_tr_b16 v[178:179], v53 offset:25088
    v_fmac_f32 v12, v220, v15
    v_fmac_f32 v13, v35, v14
    v_fma_f32 v14, v34, v12, v66
    v_mfma_f32_32x32x16_bf16 v[108:123], v[160:163], a[16:19], v[108:123]
    ds_read_b64_tr_b16 v[180:181], v51 offset:26624
    ds_read_b64_tr_b16 v[182:183], v51 offset:27136
    buffer_load_dwordx4 v28, s[60:63], s98 offen offset:2048 lds
    v_fma_f32 v15, v34, v13, v82
    v_fmac_f32 v14, v220, v13
    v_fmac_f32 v15, v35, v12
    s_waitcnt lgkmcnt(6)
    v_mfma_f32_32x32x16_bf16 v[92:107], v[164:167], a[20:23], v[92:107]
    ds_read_b64_tr_b16 v[184:185], v53 offset:26624
    ds_read_b64_tr_b16 v[186:187], v53 offset:27136
    v_fma_f32 v12, v34, v14, v67
    v_fma_f32 v13, v34, v15, v83
    v_fmac_f32 v12, v220, v15
    s_waitcnt vmcnt(15)
    s_barrier
    v_mfma_f32_32x32x16_bf16 v[108:123], v[168:171], a[20:23], v[108:123]
    ds_read_b64_tr_b16 v[156:157], v50 offset:8192
    ds_read_b64_tr_b16 v[158:159], v50 offset:8704
    buffer_load_dwordx4 v29, s[60:63], s98 offen offset:3072 lds
    v_fmac_f32 v13, v35, v14
    v_fma_f32 v14, v34, v12, v68
    v_fma_f32 v15, v34, v13, v84
    s_waitcnt lgkmcnt(6)
    v_mfma_f32_32x32x16_bf16 v[92:107], v[172:175], a[24:27], v[92:107]
    ds_read_b64_tr_b16 v[160:161], v52 offset:8192
    ds_read_b64_tr_b16 v[162:163], v52 offset:8704
    v_fmac_f32 v14, v220, v13
    v_fmac_f32 v15, v35, v12
    v_fma_f32 v12, v34, v14, v69
    v_mfma_f32_32x32x16_bf16 v[108:123], v[176:179], a[24:27], v[108:123]
    ds_read_b64_tr_b16 v[164:165], v50 offset:10240
    ds_read_b64_tr_b16 v[166:167], v50 offset:10752
    s_add_u32 m0, s82, 0x8000
    s_mul_i32 s98, s22, 0x700
    s_add_u32 s98, s98, s43
    buffer_load_dwordx4 v26, s[60:63], s98 offen lds
    v_fma_f32 v13, v34, v15, v85
    v_fmac_f32 v12, v220, v15
    v_fmac_f32 v13, v35, v14
    s_waitcnt lgkmcnt(6)
    v_mfma_f32_32x32x16_bf16 v[92:107], v[180:183], a[28:31], v[92:107]
    ds_read_b64_tr_b16 v[168:169], v52 offset:10240
    ds_read_b64_tr_b16 v[170:171], v52 offset:10752
    v_fma_f32 v14, v34, v12, v70
    v_fma_f32 v15, v34, v13, v86
    v_fmac_f32 v14, v220, v13
    v_mfma_f32_32x32x16_bf16 v[108:123], v[184:187], a[28:31], v[108:123]
    ds_read_b64_tr_b16 v[172:173], v51 offset:8192
    ds_read_b64_tr_b16 v[174:175], v51 offset:8704
    buffer_load_dwordx4 v27, s[60:63], s98 offen offset:1024 lds
    v_fmac_f32 v15, v35, v12
    v_fma_f32 v12, v34, v14, v71
    v_fma_f32 v13, v34, v15, v87
    s_waitcnt lgkmcnt(6)
    v_mfma_f32_32x32x16_bf16 v[92:107], v[156:159], a[32:35], v[92:107]
    ds_read_b64_tr_b16 v[176:177], v53 offset:8192
    ds_read_b64_tr_b16 v[178:179], v53 offset:8704
    v_fmac_f32 v12, v220, v15
    v_fmac_f32 v13, v35, v14
    v_fma_f32 v14, v34, v12, v72
    v_mfma_f32_32x32x16_bf16 v[108:123], v[160:163], a[32:35], v[108:123]
    ds_read_b64_tr_b16 v[180:181], v51 offset:10240
    ds_read_b64_tr_b16 v[182:183], v51 offset:10752
    buffer_load_dwordx4 v28, s[60:63], s98 offen offset:2048 lds
    v_fma_f32 v15, v34, v13, v88
    v_fmac_f32 v14, v220, v13
    v_fmac_f32 v15, v35, v12
    s_waitcnt lgkmcnt(6)
    v_mfma_f32_32x32x16_bf16 v[92:107], v[164:167], a[36:39], v[92:107]
    ds_read_b64_tr_b16 v[184:185], v53 offset:10240
    ds_read_b64_tr_b16 v[186:187], v53 offset:10752
    v_fma_f32 v12, v34, v14, v73
    v_fma_f32 v13, v34, v15, v89
    v_fmac_f32 v12, v220, v15
    s_waitcnt vmcnt(15)
    s_barrier
    v_mfma_f32_32x32x16_bf16 v[108:123], v[168:171], a[36:39], v[108:123]
    ds_read_b64_tr_b16 v[156:157], v50 offset:12288
    ds_read_b64_tr_b16 v[158:159], v50 offset:12800
    buffer_load_dwordx4 v29, s[60:63], s98 offen offset:3072 lds
    v_fmac_f32 v13, v35, v14
    v_fma_f32 v14, v34, v12, v74
    v_fma_f32 v15, v34, v13, v90
    s_waitcnt lgkmcnt(6)
    v_mfma_f32_32x32x16_bf16 v[92:107], v[172:175], a[40:43], v[92:107]
    ds_read_b64_tr_b16 v[160:161], v52 offset:12288
    ds_read_b64_tr_b16 v[162:163], v52 offset:12800
    v_fmac_f32 v14, v220, v13
    v_fmac_f32 v15, v35, v12
    v_fma_f32 v12, v34, v14, v75
    v_mfma_f32_32x32x16_bf16 v[108:123], v[176:179], a[40:43], v[108:123]
    ds_read_b64_tr_b16 v[164:165], v50 offset:14336
    ds_read_b64_tr_b16 v[166:167], v50 offset:14848
    s_add_u32 m0, s82, 0
    s_mul_i32 s98, s23, 0x700
    s_add_u32 s98, s98, s43
    buffer_load_dwordx4 v26, s[60:63], s98 offen lds
    v_fma_f32 v13, v34, v15, v91
    v_fmac_f32 v12, v220, v15
    v_fmac_f32 v13, v35, v14
    s_waitcnt lgkmcnt(6)
    v_mfma_f32_32x32x16_bf16 v[92:107], v[180:183], a[44:47], v[92:107]
    ds_read_b64_tr_b16 v[168:169], v52 offset:14336
    ds_read_b64_tr_b16 v[170:171], v52 offset:14848
    v_mul_f32 v16, v58, v12
    v_mul_f32 v18, v58, v13
    v_fma_f32 v16, -v59, v13, v16
    v_mfma_f32_32x32x16_bf16 v[108:123], v[184:187], a[44:47], v[108:123]
    ds_read_b64_tr_b16 v[172:173], v51 offset:12288
    ds_read_b64_tr_b16 v[174:175], v51 offset:12800
    buffer_load_dwordx4 v27, s[60:63], s98 offen offset:1024 lds
    v_fmac_f32 v18, v59, v12
    v_mov_b32 v17, s83
    v_mov_b32 v223, v16
    s_waitcnt lgkmcnt(6)
    v_mfma_f32_32x32x16_bf16 v[92:107], v[156:159], a[48:51], v[92:107]
    ds_read_b64_tr_b16 v[176:177], v53 offset:12288
    ds_read_b64_tr_b16 v[178:179], v53 offset:12800
    v_mov_b32 v224, v18
    v_mov_b32 v19, s83
    v_permlane32_swap_b32 v223, v16
    v_mfma_f32_32x32x16_bf16 v[108:123], v[160:163], a[48:51], v[108:123]
    ds_read_b64_tr_b16 v[180:181], v51 offset:14336
    ds_read_b64_tr_b16 v[182:183], v51 offset:14848
    buffer_load_dwordx4 v28, s[60:63], s98 offen offset:2048 lds
    v_permlane32_swap_b32 v224, v18
    v_fmac_f32 v16, v221, v223
    v_fmac_f32 v18, v221, v224
    s_waitcnt lgkmcnt(6)
    v_mfma_f32_32x32x16_bf16 v[92:107], v[164:167], a[52:55], v[92:107]
    ds_read_b64_tr_b16 v[184:185], v53 offset:14336
    ds_read_b64_tr_b16 v[186:187], v53 offset:14848
    v_fma_f32 v16, -v222, v224, v16
    v_fmac_f32 v18, v222, v223
    s_mov_b32 exec_hi, 0
    buffer_store_dwordx4 v[16:19], v227, s[64:67], 0 offen sc1
    s_mov_b32 exec_hi, -1
    v_add_u32 v227, 0x80000, v227
    s_waitcnt vmcnt(16)
    s_barrier
    v_mfma_f32_32x32x16_bf16 v[108:123], v[168:171], a[52:55], v[108:123]
    ds_read_b64_tr_b16 v[156:157], v50 offset:28672
    ds_read_b64_tr_b16 v[158:159], v50 offset:29184
    buffer_load_dwordx4 v29, s[60:63], s98 offen offset:3072 lds
    s_waitcnt lgkmcnt(6)
    v_mfma_f32_32x32x16_bf16 v[92:107], v[172:175], a[56:59], v[92:107]
    ds_read_b64_tr_b16 v[160:161], v52 offset:28672
    ds_read_b64_tr_b16 v[162:163], v52 offset:29184
    v_mul_f32 v12, v59, v60
    v_mul_f32 v60, v58, v60
    v_fma_f32 v60, -v59, v76, v60
    v_mfma_f32_32x32x16_bf16 v[108:123], v[176:179], a[56:59], v[108:123]
    ds_read_b64_tr_b16 v[164:165], v50 offset:30720
    ds_read_b64_tr_b16 v[166:167], v50 offset:31232
    s_add_u32 m0, s82, 0x9000
    s_mul_i32 s98, s24, 0x700
    s_add_u32 s98, s98, s43
    buffer_load_dwordx4 v26, s[60:63], s98 offen lds
    v_fma_f32 v76, v58, v76, v12
    v_mul_f32 v13, v59, v61
    v_mul_f32 v61, v58, v61
    s_waitcnt lgkmcnt(6)
    v_mfma_f32_32x32x16_bf16 v[92:107], v[180:183], a[60:63], v[92:107]
    ds_read_b64_tr_b16 v[168:169], v52 offset:30720
    ds_read_b64_tr_b16 v[170:171], v52 offset:31232
    v_fma_f32 v61, -v59, v77, v61
    v_fma_f32 v77, v58, v77, v13
    v_mfma_f32_32x32x16_bf16 v[108:123], v[184:187], a[60:63], v[108:123]
    ds_read_b64_tr_b16 v[172:173], v51 offset:28672
    ds_read_b64_tr_b16 v[174:175], v51 offset:29184
    buffer_load_dwordx4 v27, s[60:63], s98 offen offset:1024 lds
    v_mul_f32 v12, v59, v62
    v_mul_f32 v62, v58, v62
    v_fma_f32 v62, -v59, v78, v62
    s_waitcnt lgkmcnt(6)
    v_mfma_f32_32x32x16_bf16 v[92:107], v[156:159], a[64:67], v[92:107]
    ds_read_b64_tr_b16 v[176:177], v53 offset:28672
    ds_read_b64_tr_b16 v[178:179], v53 offset:29184
    v_fma_f32 v78, v58, v78, v12
    v_mul_f32 v13, v59, v63
    v_mul_f32 v63, v58, v63
    v_mfma_f32_32x32x16_bf16 v[108:123], v[160:163], a[64:67], v[108:123]
    ds_read_b64_tr_b16 v[180:181], v51 offset:30720
    ds_read_b64_tr_b16 v[182:183], v51 offset:31232
    buffer_load_dwordx4 v28, s[60:63], s98 offen offset:2048 lds
    v_fma_f32 v63, -v59, v79, v63
    v_fma_f32 v79, v58, v79, v13
    s_waitcnt lgkmcnt(6)
    v_mfma_f32_32x32x16_bf16 v[92:107], v[164:167], a[68:71], v[92:107]
    ds_read_b64_tr_b16 v[184:185], v53 offset:30720
    ds_read_b64_tr_b16 v[186:187], v53 offset:31232
    v_mul_f32 v12, v59, v64
    v_mul_f32 v64, v58, v64
    v_fma_f32 v64, -v59, v80, v64
    s_waitcnt vmcnt(16)
    s_barrier
    v_mfma_f32_32x32x16_bf16 v[108:123], v[168:171], a[68:71], v[108:123]
    ds_read_b64_tr_b16 v[156:157], v50 offset:16384
    ds_read_b64_tr_b16 v[158:159], v50 offset:16896
    buffer_load_dwordx4 v29, s[60:63], s98 offen offset:3072 lds
    v_fma_f32 v80, v58, v80, v12
    v_mul_f32 v13, v59, v65
    v_mul_f32 v65, v58, v65
    s_waitcnt lgkmcnt(6)
    v_mfma_f32_32x32x16_bf16 v[92:107], v[172:175], a[72:75], v[92:107]
    ds_read_b64_tr_b16 v[160:161], v52 offset:16384
    ds_read_b64_tr_b16 v[162:163], v52 offset:16896
    v_fma_f32 v65, -v59, v81, v65
    v_fma_f32 v81, v58, v81, v13
    v_mfma_f32_32x32x16_bf16 v[108:123], v[176:179], a[72:75], v[108:123]
    ds_read_b64_tr_b16 v[164:165], v50 offset:18432
    ds_read_b64_tr_b16 v[166:167], v50 offset:18944
    s_add_u32 m0, s82, 0x1000
    s_mul_i32 s98, s25, 0x700
    s_add_u32 s98, s98, s43
    buffer_load_dwordx4 v26, s[60:63], s98 offen lds
    v_mul_f32 v12, v59, v66
    v_mul_f32 v66, v58, v66
    v_fma_f32 v66, -v59, v82, v66
    s_waitcnt lgkmcnt(6)
    v_mfma_f32_32x32x16_bf16 v[92:107], v[180:183], a[76:79], v[92:107]
    ds_read_b64_tr_b16 v[168:169], v52 offset:18432
    ds_read_b64_tr_b16 v[170:171], v52 offset:18944
    v_fma_f32 v82, v58, v82, v12
    v_mul_f32 v13, v59, v67
    v_mul_f32 v67, v58, v67
    v_mfma_f32_32x32x16_bf16 v[108:123], v[184:187], a[76:79], v[108:123]
    ds_read_b64_tr_b16 v[172:173], v51 offset:16384
    ds_read_b64_tr_b16 v[174:175], v51 offset:16896
    buffer_load_dwordx4 v27, s[60:63], s98 offen offset:1024 lds
    v_fma_f32 v67, -v59, v83, v67
    v_fma_f32 v83, v58, v83, v13
    s_waitcnt lgkmcnt(6)
    v_mfma_f32_32x32x16_bf16 v[92:107], v[156:159], a[80:83], v[92:107]
    ds_read_b64_tr_b16 v[176:177], v53 offset:16384
    ds_read_b64_tr_b16 v[178:179], v53 offset:16896
    v_mul_f32 v12, v59, v68
    v_mul_f32 v68, v58, v68
    v_fma_f32 v68, -v59, v84, v68
    buffer_load_dwordx2 v[228:229], v225, s[64:67], 0 offen sc1
    buffer_load_dwordx2 v[230:231], v226, s[64:67], 0 offen sc1
    v_mfma_f32_32x32x16_bf16 v[108:123], v[160:163], a[80:83], v[108:123]
    ds_read_b64_tr_b16 v[180:181], v51 offset:18432
    ds_read_b64_tr_b16 v[182:183], v51 offset:18944
    buffer_load_dwordx4 v28, s[60:63], s98 offen offset:2048 lds
    v_fma_f32 v84, v58, v84, v12
    v_mul_f32 v13, v59, v69
    v_mul_f32 v69, v58, v69
    s_waitcnt lgkmcnt(6)
    v_mfma_f32_32x32x16_bf16 v[92:107], v[164:167], a[84:87], v[92:107]
    ds_read_b64_tr_b16 v[184:185], v53 offset:18432
    ds_read_b64_tr_b16 v[186:187], v53 offset:18944
    v_fma_f32 v69, -v59, v85, v69
    v_fma_f32 v85, v58, v85, v13
    s_waitcnt vmcnt(18)
    s_barrier
    v_mfma_f32_32x32x16_bf16 v[108:123], v[168:171], a[84:87], v[108:123]
    ds_read_b64_tr_b16 v[156:157], v50 offset:20480
    ds_read_b64_tr_b16 v[158:159], v50 offset:20992
    buffer_load_dwordx4 v29, s[60:63], s98 offen offset:3072 lds
    v_mul_f32 v12, v59, v70
    v_mul_f32 v70, v58, v70
    v_fma_f32 v70, -v59, v86, v70
    s_waitcnt lgkmcnt(6)
    v_mfma_f32_32x32x16_bf16 v[92:107], v[172:175], a[88:91], v[92:107]
    ds_read_b64_tr_b16 v[160:161], v52 offset:20480
    ds_read_b64_tr_b16 v[162:163], v52 offset:20992
    v_fma_f32 v86, v58, v86, v12
    v_mul_f32 v13, v59, v71
    v_mul_f32 v71, v58, v71
    v_mfma_f32_32x32x16_bf16 v[108:123], v[176:179], a[88:91], v[108:123]
    ds_read_b64_tr_b16 v[164:165], v50 offset:22528
    ds_read_b64_tr_b16 v[166:167], v50 offset:23040
    s_add_u32 m0, s82, 0x6000
    s_mul_i32 s98, s34, 0x700
    s_add_u32 s98, s98, s43
    buffer_load_dwordx4 v26, s[60:63], s98 offen lds
    v_fma_f32 v71, -v59, v87, v71
    v_fma_f32 v87, v58, v87, v13
    s_waitcnt lgkmcnt(6)
    v_mfma_f32_32x32x16_bf16 v[92:107], v[180:183], a[92:95], v[92:107]
    ds_read_b64_tr_b16 v[168:169], v52 offset:22528
    ds_read_b64_tr_b16 v[170:171], v52 offset:23040
    v_mul_f32 v12, v59, v72
    v_mul_f32 v72, v58, v72
    v_fma_f32 v72, -v59, v88, v72
    v_mfma_f32_32x32x16_bf16 v[108:123], v[184:187], a[92:95], v[108:123]
    ds_read_b64_tr_b16 v[172:173], v51 offset:20480
    ds_read_b64_tr_b16 v[174:175], v51 offset:20992
    buffer_load_dwordx4 v27, s[60:63], s98 offen offset:1024 lds
    v_fma_f32 v88, v58, v88, v12
    v_mul_f32 v13, v59, v73
    v_mul_f32 v73, v58, v73
    s_waitcnt lgkmcnt(6)
    v_mfma_f32_32x32x16_bf16 v[92:107], v[156:159], a[96:99], v[92:107]
    ds_read_b64_tr_b16 v[176:177], v53 offset:20480
    ds_read_b64_tr_b16 v[178:179], v53 offset:20992
    v_fma_f32 v73, -v59, v89, v73
    v_fma_f32 v89, v58, v89, v13
    v_mfma_f32_32x32x16_bf16 v[108:123], v[160:163], a[96:99], v[108:123]
    ds_read_b64_tr_b16 v[180:181], v51 offset:22528
    ds_read_b64_tr_b16 v[182:183], v51 offset:23040
    buffer_load_dwordx4 v28, s[60:63], s98 offen offset:2048 lds
    v_mul_f32 v12, v59, v74
    v_mul_f32 v74, v58, v74
    v_fma_f32 v74, -v59, v90, v74
    s_waitcnt lgkmcnt(6)
    v_mfma_f32_32x32x16_bf16 v[92:107], v[164:167], a[100:103], v[92:107]
    ds_read_b64_tr_b16 v[184:185], v53 offset:22528
    ds_read_b64_tr_b16 v[186:187], v53 offset:23040
    v_fma_f32 v90, v58, v90, v12
    v_mul_f32 v13, v59, v75
    v_mul_f32 v75, v58, v75
    s_waitcnt vmcnt(18)
    s_barrier
    v_mfma_f32_32x32x16_bf16 v[108:123], v[168:171], a[100:103], v[108:123]
    ds_read_b64_tr_b16 v[156:157], v50 offset:32768
    ds_read_b64_tr_b16 v[158:159], v50 offset:33280
    buffer_load_dwordx4 v29, s[60:63], s98 offen offset:3072 lds
    v_fma_f32 v75, -v59, v91, v75
    v_fma_f32 v91, v58, v91, v13
    s_waitcnt lgkmcnt(6)
    v_mfma_f32_32x32x16_bf16 v[92:107], v[172:175], a[104:107], v[92:107]
    ds_read_b64_tr_b16 v[160:161], v52 offset:32768
    ds_read_b64_tr_b16 v[162:163], v52 offset:33280
    v_mfma_f32_32x32x16_bf16 v[108:123], v[176:179], a[104:107], v[108:123]
    ds_read_b64_tr_b16 v[164:165], v50 offset:34816
    ds_read_b64_tr_b16 v[166:167], v50 offset:35328
    s_add_u32 m0, s82, 0x2000
    s_mul_i32 s98, s35, 0x700
    s_add_u32 s98, s98, s43
    buffer_load_dwordx4 v26, s[60:63], s98 offen lds
    s_waitcnt lgkmcnt(6)
    v_mfma_f32_32x32x16_bf16 v[92:107], v[180:183], a[108:111], v[92:107]
    ds_read_b64_tr_b16 v[168:169], v52 offset:34816
    ds_read_b64_tr_b16 v[170:171], v52 offset:35328
    s_lshr_b32 s6, s83, 3
    s_lshr_b32 s7, s83, 7
    s_mul_i32 s7, s7, 0x9e3779b1
    v_and_b32 v5, 7, v1
    v_lshlrev_b32 v6, 2, v5
    v_lshrrev_b32 v4, v6, s7
    v_and_b32 v4, 8, v4
    v_add3_u32 v4, v4, v5, s6
    v_bfe_u32 v7, v4, 3, 1
    v_bfe_u32 v6, v4, 2, 1
    v_bfe_u32 v5, v4, 1, 1
    v_bfe_u32 v4, v4, 0, 1
    v_lshlrev_b32 v247, 16, v4
    v_lshlrev_b32 v248, 16, v5
    v_lshlrev_b32 v249, 16, v6
    v_lshlrev_b32 v250, 16, v7
    s_mov_b32 s92, 0xfffe0000
    v_mfma_f32_32x32x16_bf16 v[108:123], v[184:187], a[108:111], v[108:123]
    ds_read_b64_tr_b16 v[172:173], v51 offset:32768
    ds_read_b64_tr_b16 v[174:175], v51 offset:33280
    buffer_load_dwordx4 v27, s[60:63], s98 offen offset:1024 lds
    s_waitcnt lgkmcnt(6)
    v_mfma_f32_32x32x16_bf16 v[124:139], v[156:159], a[0:3], 0
    ds_read_b64_tr_b16 v[176:177], v53 offset:32768
    ds_read_b64_tr_b16 v[178:179], v53 offset:33280
    v_mfma_f32_32x32x16_bf16 v[140:155], v[160:163], a[0:3], 0
    ds_read_b64_tr_b16 v[180:181], v51 offset:34816
    ds_read_b64_tr_b16 v[182:183], v51 offset:35328
    buffer_load_dwordx4 v28, s[60:63], s98 offen offset:2048 lds
    s_waitcnt lgkmcnt(6)
    v_mfma_f32_32x32x16_bf16 v[124:139], v[164:167], a[4:7], v[124:139]
    ds_read_b64_tr_b16 v[184:185], v53 offset:34816
    ds_read_b64_tr_b16 v[186:187], v53 offset:35328
    s_waitcnt vmcnt(10)
    v_cmp_ne_u32 vcc, s83, v229
    s_waitcnt vmcnt(9)
    v_cmp_ne_u32 s[12:13], s83, v231
    s_nop 0
    s_or_b64 vcc, vcc, s[12:13]
    s_nop 0
    s_cmp_lg_u64 vcc, 0
    s_cbranch_scc1 SPIN_1
RES_2:
    v_sub_f32 v228, 1.0, v228
    v_cvt_pk_bf16_f32 v228, 0, v228
    v_rcp_f32 v228, v228
    s_nop 0
    v_min_f32 v228, 0x7f000000, v228
    s_barrier
    v_mfma_f32_32x32x16_bf16 v[140:155], v[168:171], a[4:7], v[140:155]
    ds_read_b64_tr_b16 v[156:157], v50
    ds_read_b64_tr_b16 v[158:159], v50 offset:512
    buffer_load_dwordx4 v29, s[60:63], s98 offen offset:3072 lds
    v_mul_f32 v8, 0xbfb8aa3b, v92
    v_mul_f32 v9, 0xbfb8aa3b, v93
    v_mul_f32 v10, 0xbfb8aa3b, v94
    v_mul_f32 v11, 0xbfb8aa3b, v95
    s_waitcnt lgkmcnt(6)
    v_mfma_f32_32x32x16_bf16 v[124:139], v[172:175], a[8:11], v[124:139]
    ds_read_b64_tr_b16 v[160:161], v52
    ds_read_b64_tr_b16 v[162:163], v52 offset:512
    v_exp_f32 v8, v8
    v_exp_f32 v9, v9
    v_mfma_f32_32x32x16_bf16 v[140:155], v[176:179], a[8:11], v[140:155]
    ds_read_b64_tr_b16 v[164:165], v50 offset:2048
    ds_read_b64_tr_b16 v[166:167], v50 offset:2560
    s_add_u32 m0, s82, 0x3000
    s_mul_i32 s98, s36, 0x700
    s_add_u32 s98, s98, s43
    buffer_load_dwordx4 v26, s[60:63], s98 offen lds
    v_exp_f32 v10, v10
    s_waitcnt lgkmcnt(6)
    v_mfma_f32_32x32x16_bf16 v[124:139], v[180:183], a[12:15], v[124:139]
    ds_read_b64_tr_b16 v[168:169], v52 offset:2048
    ds_read_b64_tr_b16 v[170:171], v52 offset:2560
    v_exp_f32 v11, v11
    v_mul_f32 v92, v92, v108
    v_mul_f32 v93, v93, v109
    v_mfma_f32_32x32x16_bf16 v[140:155], v[184:187], a[12:15], v[140:155]
    ds_read_b64_tr_b16 v[172:173], v51
    ds_read_b64_tr_b16 v[174:175], v51 offset:512
    buffer_load_dwordx4 v27, s[60:63], s98 offen offset:1024 lds
    v_mul_f32 v94, v94, v110
    v_mul_f32 v95, v95, v111
    v_fma_f32 v8, v8, v228, v228
    s_waitcnt lgkmcnt(6)
    v_mfma_f32_32x32x16_bf16 v[124:139], v[156:159], a[16:19], v[124:139]
    ds_read_b64_tr_b16 v[176:177], v53
    ds_read_b64_tr_b16 v[178:179], v53 offset:512
    v_fma_f32 v9, v9, v228, v228
    v_fma_f32 v10, v10, v228, v228
    v_fma_f32 v11, v11, v228, v228
    v_mfma_f32_32x32x16_bf16 v[140:155], v[160:163], a[16:19], v[140:155]
    ds_read_b64_tr_b16 v[180:181], v51 offset:2048
    ds_read_b64_tr_b16 v[182:183], v51 offset:2560
    buffer_load_dwordx4 v28, s[60:63], s98 offen offset:2048 lds
    v_rcp_f32 v8, v8
    v_rcp_f32 v9, v9
    s_waitcnt lgkmcnt(6)
    v_mfma_f32_32x32x16_bf16 v[124:139], v[164:167], a[20:23], v[124:139]
    ds_read_b64_tr_b16 v[184:185], v53 offset:2048
    ds_read_b64_tr_b16 v[186:187], v53 offset:2560
    v_rcp_f32 v10, v10
    v_rcp_f32 v11, v11
    s_barrier
    v_mfma_f32_32x32x16_bf16 v[140:155], v[168:171], a[20:23], v[140:155]
    ds_read_b64_tr_b16 v[156:157], v50 offset:36864
    ds_read_b64_tr_b16 v[158:159], v50 offset:37376
    buffer_load_dwordx4 v29, s[60:63], s98 offen offset:3072 lds
    v_mul_f32 v92, v92, v8
    v_mul_f32 v93, v93, v9
    s_waitcnt lgkmcnt(6)
    v_mfma_f32_32x32x16_bf16 v[124:139], v[172:175], a[24:27], v[124:139]
    ds_read_b64_tr_b16 v[160:161], v52 offset:36864
    ds_read_b64_tr_b16 v[162:163], v52 offset:37376
    v_mul_f32 v94, v94, v10
    v_mul_f32 v95, v95, v11
    v_cvt_pk_bf16_f32 v188, v92, v93
    v_mfma_f32_32x32x16_bf16 v[140:155], v[176:179], a[24:27], v[140:155]
    ds_read_b64_tr_b16 v[164:165], v50 offset:38912
    ds_read_b64_tr_b16 v[166:167], v50 offset:39424
    s_add_u32 m0, s82, 0x7000
    s_mul_i32 s98, s22, 0x700
    s_add_u32 s98, s98, s46
    buffer_load_dwordx4 v26, s[60:63], s98 offen lds
    v_cvt_pk_bf16_f32 v189, v94, v95
    v_mul_f32 v8, 0xbfb8aa3b, v96
    v_mul_f32 v9, 0xbfb8aa3b, v97
    v_mul_f32 v10, 0xbfb8aa3b, v98
    s_waitcnt lgkmcnt(6)
    v_mfma_f32_32x32x16_bf16 v[124:139], v[180:183], a[28:31], v[124:139]
    ds_read_b64_tr_b16 v[168:169], v52 offset:38912
    ds_read_b64_tr_b16 v[170:171], v52 offset:39424
    v_mul_f32 v11, 0xbfb8aa3b, v99
    v_exp_f32 v8, v8
    v_mfma_f32_32x32x16_bf16 v[140:155], v[184:187], a[28:31], v[140:155]
    ds_read_b64_tr_b16 v[172:173], v51 offset:36864
    ds_read_b64_tr_b16 v[174:175], v51 offset:37376
    buffer_load_dwordx4 v27, s[60:63], s98 offen offset:1024 lds
    v_exp_f32 v9, v9
    v_exp_f32 v10, v10
    s_waitcnt lgkmcnt(6)
    v_mfma_f32_32x32x16_bf16 v[124:139], v[156:159], a[32:35], v[124:139]
    ds_read_b64_tr_b16 v[176:177], v53 offset:36864
    ds_read_b64_tr_b16 v[178:179], v53 offset:37376
    v_exp_f32 v11, v11
    v_mfma_f32_32x32x16_bf16 v[140:155], v[160:163], a[32:35], v[140:155]
    ds_read_b64_tr_b16 v[180:181], v51 offset:38912
    ds_read_b64_tr_b16 v[182:183], v51 offset:39424
    buffer_load_dwordx4 v28, s[60:63], s98 offen offset:2048 lds
    v_mul_f32 v96, v96, v112
    v_mul_f32 v97, v97, v113
    v_mul_f32 v98, v98, v114
    v_mul_f32 v99, v99, v115
    s_waitcnt lgkmcnt(6)
    v_mfma_f32_32x32x16_bf16 v[124:139], v[164:167], a[36:39], v[124:139]
    ds_read_b64_tr_b16 v[184:185], v53 offset:38912
    ds_read_b64_tr_b16 v[186:187], v53 offset:39424
    v_fma_f32 v8, v8, v228, v228
    v_fma_f32 v9, v9, v228, v228
    v_fma_f32 v10, v10, v228, v228
    s_waitcnt vmcnt(15)
    s_barrier
    v_mfma_f32_32x32x16_bf16 v[140:155], v[168:171], a[36:39], v[140:155]
    ds_read_b64_tr_b16 v[156:157], v50 offset:4096
    ds_read_b64_tr_b16 v[158:159], v50 offset:4608
    buffer_load_dwordx4 v29, s[60:63], s98 offen offset:3072 lds
    v_fma_f32 v11, v11, v228, v228
    v_rcp_f32 v8, v8
    s_waitcnt lgkmcnt(6)
    v_mfma_f32_32x32x16_bf16 v[124:139], v[172:175], a[40:43], v[124:139]
    ds_read_b64_tr_b16 v[160:161], v52 offset:4096
    ds_read_b64_tr_b16 v[162:163], v52 offset:4608
    v_rcp_f32 v9, v9
    v_rcp_f32 v10, v10
    v_mfma_f32_32x32x16_bf16 v[140:155], v[176:179], a[40:43], v[140:155]
    ds_read_b64_tr_b16 v[164:165], v50 offset:6144
    ds_read_b64_tr_b16 v[166:167], v50 offset:6656
    s_add_u32 m0, s82, 0x4000
    s_mul_i32 s98, s23, 0x700
    s_add_u32 s98, s98, s46
    buffer_load_dwordx4 v26, s[60:63], s98 offen lds
    v_rcp_f32 v11, v11
    v_mul_f32 v96, v96, v8
    s_waitcnt lgkmcnt(6)
    v_mfma_f32_32x32x16_bf16 v[124:139], v[180:183], a[44:47], v[124:139]
    ds_read_b64_tr_b16 v[168:169], v52 offset:6144
    ds_read_b64_tr_b16 v[170:171], v52 offset:6656
    v_mul_f32 v97, v97, v9
    v_mul_f32 v98, v98, v10
    v_mul_f32 v99, v99, v11
    v_mfma_f32_32x32x16_bf16 v[140:155], v[184:187], a[44:47], v[140:155]
    ds_read_b64_tr_b16 v[172:173], v51 offset:4096
    ds_read_b64_tr_b16 v[174:175], v51 offset:4608
    buffer_load_dwordx4 v27, s[60:63], s98 offen offset:1024 lds
    v_cvt_pk_bf16_f32 v190, v96, v97
    v_cvt_pk_bf16_f32 v191, v98, v99
    v_mul_f32 v8, 0xbfb8aa3b, v100
    s_waitcnt lgkmcnt(6)
    v_mfma_f32_32x32x16_bf16 v[124:139], v[156:159], a[48:51], v[124:139]
    ds_read_b64_tr_b16 v[176:177], v53 offset:4096
    ds_read_b64_tr_b16 v[178:179], v53 offset:4608
    v_mul_f32 v9, 0xbfb8aa3b, v101
    v_mul_f32 v10, 0xbfb8aa3b, v102
    v_mul_f32 v11, 0xbfb8aa3b, v103
    v_exp_f32 v8, v8
    v_mfma_f32_32x32x16_bf16 v[140:155], v[160:163], a[48:51], v[140:155]
    ds_read_b64_tr_b16 v[180:181], v51 offset:6144
    ds_read_b64_tr_b16 v[182:183], v51 offset:6656
    buffer_load_dwordx4 v28, s[60:63], s98 offen offset:2048 lds
    v_exp_f32 v9, v9
    s_waitcnt lgkmcnt(6)
    v_mfma_f32_32x32x16_bf16 v[124:139], v[164:167], a[52:55], v[124:139]
    ds_read_b64_tr_b16 v[184:185], v53 offset:6144
    ds_read_b64_tr_b16 v[186:187], v53 offset:6656
    v_exp_f32 v10, v10
    v_exp_f32 v11, v11
    s_waitcnt vmcnt(15)
    s_barrier
    v_mfma_f32_32x32x16_bf16 v[140:155], v[168:171], a[52:55], v[140:155]
    ds_read_b64_tr_b16 v[156:157], v50 offset:24576
    ds_read_b64_tr_b16 v[158:159], v50 offset:25088
    buffer_load_dwordx4 v29, s[60:63], s98 offen offset:3072 lds
    v_mul_f32 v100, v100, v116
    v_mul_f32 v101, v101, v117
    v_mul_f32 v102, v102, v118
    s_waitcnt lgkmcnt(6)
    v_mfma_f32_32x32x16_bf16 v[124:139], v[172:175], a[56:59], v[124:139]
    ds_read_b64_tr_b16 v[160:161], v52 offset:24576
    ds_read_b64_tr_b16 v[162:163], v52 offset:25088
    v_mul_f32 v103, v103, v119
    v_fma_f32 v8, v8, v228, v228
    v_fma_f32 v9, v9, v228, v228
    v_mfma_f32_32x32x16_bf16 v[140:155], v[176:179], a[56:59], v[140:155]
    ds_read_b64_tr_b16 v[164:165], v50 offset:26624
    ds_read_b64_tr_b16 v[166:167], v50 offset:27136
    s_add_u32 m0, s82, 0x5000
    s_mul_i32 s98, s24, 0x700
    s_add_u32 s98, s98, s46
    buffer_load_dwordx4 v26, s[60:63], s98 offen lds
    v_fma_f32 v10, v10, v228, v228
    v_fma_f32 v11, v11, v228, v228
    v_rcp_f32 v8, v8
    s_waitcnt lgkmcnt(6)
    v_mfma_f32_32x32x16_bf16 v[124:139], v[180:183], a[60:63], v[124:139]
    ds_read_b64_tr_b16 v[168:169], v52 offset:26624
    ds_read_b64_tr_b16 v[170:171], v52 offset:27136
    v_rcp_f32 v9, v9
    v_mfma_f32_32x32x16_bf16 v[140:155], v[184:187], a[60:63], v[140:155]
    ds_read_b64_tr_b16 v[172:173], v51 offset:24576
    ds_read_b64_tr_b16 v[174:175], v51 offset:25088
    buffer_load_dwordx4 v27, s[60:63], s98 offen offset:1024 lds
    v_rcp_f32 v10, v10
    v_rcp_f32 v11, v11
    s_waitcnt lgkmcnt(6)
    v_mfma_f32_32x32x16_bf16 v[124:139], v[156:159], a[64:67], v[124:139]
    ds_read_b64_tr_b16 v[176:177], v53 offset:24576
    ds_read_b64_tr_b16 v[178:179], v53 offset:25088
    v_mul_f32 v100, v100, v8
    v_mul_f32 v101, v101, v9
    v_mul_f32 v102, v102, v10
    v_mfma_f32_32x32x16_bf16 v[140:155], v[160:163], a[64:67], v[140:155]
    ds_read_b64_tr_b16 v[180:181], v51 offset:26624
    ds_read_b64_tr_b16 v[182:183], v51 offset:27136
    buffer_load_dwordx4 v28, s[60:63], s98 offen offset:2048 lds
    v_mul_f32 v103, v103, v11
    v_cvt_pk_bf16_f32 v192, v100, v101
    v_cvt_pk_bf16_f32 v193, v102, v103
    s_waitcnt lgkmcnt(6)
    v_mfma_f32_32x32x16_bf16 v[124:139], v[164:167], a[68:71], v[124:139]
    ds_read_b64_tr_b16 v[184:185], v53 offset:26624
    ds_read_b64_tr_b16 v[186:187], v53 offset:27136
    v_mul_f32 v8, 0xbfb8aa3b, v104
    v_mul_f32 v9, 0xbfb8aa3b, v105
    v_mul_f32 v10, 0xbfb8aa3b, v106
    v_mul_f32 v11, 0xbfb8aa3b, v107
    s_waitcnt vmcnt(15)
    s_barrier
    v_mfma_f32_32x32x16_bf16 v[140:155], v[168:171], a[68:71], v[140:155]
    ds_read_b64_tr_b16 v[156:157], v50 offset:8192
    ds_read_b64_tr_b16 v[158:159], v50 offset:8704
    buffer_load_dwordx4 v29, s[60:63], s98 offen offset:3072 lds
    v_exp_f32 v8, v8
    v_exp_f32 v9, v9
    s_waitcnt lgkmcnt(6)
    v_mfma_f32_32x32x16_bf16 v[124:139], v[172:175], a[72:75], v[124:139]
    ds_read_b64_tr_b16 v[160:161], v52 offset:8192
    ds_read_b64_tr_b16 v[162:163], v52 offset:8704
    v_exp_f32 v10, v10
    v_mfma_f32_32x32x16_bf16 v[140:155], v[176:179], a[72:75], v[140:155]
    ds_read_b64_tr_b16 v[164:165], v50 offset:10240
    ds_read_b64_tr_b16 v[166:167], v50 offset:10752
    s_add_u32 m0, s82, 0x8000
    s_mul_i32 s98, s25, 0x700
    s_add_u32 s98, s98, s46
    buffer_load_dwordx4 v26, s[60:63], s98 offen lds
    v_exp_f32 v11, v11
    v_mul_f32 v104, v104, v120
    s_waitcnt lgkmcnt(6)
    v_mfma_f32_32x32x16_bf16 v[124:139], v[180:183], a[76:79], v[124:139]
    ds_read_b64_tr_b16 v[168:169], v52 offset:10240
    ds_read_b64_tr_b16 v[170:171], v52 offset:10752
    v_mul_f32 v105, v105, v121
    v_mul_f32 v106, v106, v122
    v_mul_f32 v107, v107, v123
    v_fma_f32 v8, v8, v228, v228
    v_mfma_f32_32x32x16_bf16 v[140:155], v[184:187], a[76:79], v[140:155]
    ds_read_b64_tr_b16 v[172:173], v51 offset:8192
    ds_read_b64_tr_b16 v[174:175], v51 offset:8704
    buffer_load_dwordx4 v27, s[60:63], s98 offen offset:1024 lds
    v_fma_f32 v9, v9, v228, v228
    v_fma_f32 v10, v10, v228, v228
    v_fma_f32 v11, v11, v228, v228
    s_waitcnt lgkmcnt(6)
    v_mfma_f32_32x32x16_bf16 v[124:139], v[156:159], a[80:83], v[124:139]
    ds_read_b64_tr_b16 v[176:177], v53 offset:8192
    ds_read_b64_tr_b16 v[178:179], v53 offset:8704
    v_rcp_f32 v8, v8
    v_rcp_f32 v9, v9
    v_mfma_f32_32x32x16_bf16 v[140:155], v[160:163], a[80:83], v[140:155]
    ds_read_b64_tr_b16 v[180:181], v51 offset:10240
    ds_read_b64_tr_b16 v[182:183], v51 offset:10752
    buffer_load_dwordx4 v28, s[60:63], s98 offen offset:2048 lds
    v_rcp_f32 v10, v10
    v_rcp_f32 v11, v11
    s_waitcnt lgkmcnt(6)
    v_mfma_f32_32x32x16_bf16 v[124:139], v[164:167], a[84:87], v[124:139]
    ds_read_b64_tr_b16 v[184:185], v53 offset:10240
    ds_read_b64_tr_b16 v[186:187], v53 offset:10752
    v_mul_f32 v104, v104, v8
    v_mul_f32 v105, v105, v9
    s_waitcnt vmcnt(15)
    s_barrier
    v_mfma_f32_32x32x16_bf16 v[140:155], v[168:171], a[84:87], v[140:155]
    ds_read_b64_tr_b16 v[156:157], v50 offset:12288
    ds_read_b64_tr_b16 v[158:159], v50 offset:12800
    buffer_load_dwordx4 v29, s[60:63], s98 offen offset:3072 lds
    v_mul_f32 v106, v106, v10
    v_mul_f32 v107, v107, v11
    v_cvt_pk_bf16_f32 v194, v104, v105
    s_waitcnt lgkmcnt(6)
    v_mfma_f32_32x32x16_bf16 v[124:139], v[172:175], a[88:91], v[124:139]
    ds_read_b64_tr_b16 v[160:161], v52 offset:12288
    ds_read_b64_tr_b16 v[162:163], v52 offset:12800
    v_cvt_pk_bf16_f32 v195, v106, v107
    v_add_u32 v38, s82, v2
    s_xor_b32 s6, s3, 1
    v_mfma_f32_32x32x16_bf16 v[140:155], v[176:179], a[88:91], v[140:155]
    ds_read_b64_tr_b16 v[164:165], v50 offset:14336
    ds_read_b64_tr_b16 v[166:167], v50 offset:14848
    s_add_u32 m0, s82, 0
    s_mul_i32 s98, s34, 0x700
    s_add_u32 s98, s98, s46
    buffer_load_dwordx4 v26, s[60:63], s98 offen lds
    s_mul_i32 s6, s6, 0xa000
    v_add_u32 v39, s6, v2
    v_lshrrev_b32 v16, 5, v1
    v_and_b32 v40, 31, v1
    s_waitcnt lgkmcnt(6)
    v_mfma_f32_32x32x16_bf16 v[124:139], v[180:183], a[92:95], v[124:139]
    ds_read_b64_tr_b16 v[168:169], v52 offset:14336
    ds_read_b64_tr_b16 v[170:171], v52 offset:14848
    v_lshlrev_b32 v40, 6, v40
    v_lshl_add_u32 v40, v16, 5, v40
    v_bfe_u32 v17, v1, 1, 2
    v_mfma_f32_32x32x16_bf16 v[140:155], v[184:187], a[92:95], v[140:155]
    ds_read_b64_tr_b16 v[172:173], v51 offset:12288
    ds_read_b64_tr_b16 v[174:175], v51 offset:12800
    buffer_load_dwordx4 v27, s[60:63], s98 offen offset:1024 lds
    v_lshlrev_b32 v17, 4, v17
    v_xor_b32 v40, v40, v17
    v_add_u32 v40, s82, v40
    s_waitcnt lgkmcnt(6)
    v_mfma_f32_32x32x16_bf16 v[124:139], v[156:159], a[96:99], v[124:139]
    ds_read_b64_tr_b16 v[176:177], v53 offset:12288
    ds_read_b64_tr_b16 v[178:179], v53 offset:12800
    v_xor_b32 v21, 16, v40
    v_bfe_u32 v17, v1, 2, 2
    v_lshl_add_u32 v41, v16, 3, v17
    v_lshlrev_b32 v41, 6, v41
    v_mfma_f32_32x32x16_bf16 v[140:155], v[160:163], a[96:99], v[140:155]
    ds_read_b64_tr_b16 v[180:181], v51 offset:14336
    ds_read_b64_tr_b16 v[182:183], v51 offset:14848
    buffer_load_dwordx4 v28, s[60:63], s98 offen offset:2048 lds
    v_and_b32 v17, 1, v1
    v_lshl_add_u32 v41, v17, 5, v41
    v_bfe_u32 v17, v1, 1, 1
    s_waitcnt lgkmcnt(6)
    v_mfma_f32_32x32x16_bf16 v[124:139], v[164:167], a[100:103], v[124:139]
    ds_read_b64_tr_b16 v[184:185], v53 offset:14336
    ds_read_b64_tr_b16 v[186:187], v53 offset:14848
    v_lshl_add_u32 v41, v17, 3, v41
    v_bfe_u32 v17, v1, 4, 1
    v_lshl_add_u32 v41, v17, 4, v41
    s_waitcnt vmcnt(15)
    s_barrier
    v_mfma_f32_32x32x16_bf16 v[140:155], v[168:171], a[100:103], v[140:155]
    ds_read_b64_tr_b16 v[156:157], v50 offset:28672
    ds_read_b64_tr_b16 v[158:159], v50 offset:29184
    buffer_load_dwordx4 v29, s[60:63], s98 offen offset:3072 lds
    v_bfe_u32 v17, v1, 3, 1
    v_lshlrev_b32 v17, 4, v17
    v_xor_b32 v41, v41, v17
    s_waitcnt lgkmcnt(6)
    v_mfma_f32_32x32x16_bf16 v[124:139], v[172:175], a[104:107], v[124:139]
    ds_read_b64_tr_b16 v[160:161], v52 offset:28672
    ds_read_b64_tr_b16 v[162:163], v52 offset:29184
    v_add_u32 v20, s6, v41
    v_add_u32 v41, s82, v41
    v_xor_b32 v245, 32, v41
    v_xor_b32 v246, 32, v20
    v_mfma_f32_32x32x16_bf16 v[140:155], v[176:179], a[104:107], v[140:155]
    ds_read_b64_tr_b16 v[164:165], v50 offset:30720
    ds_read_b64_tr_b16 v[166:167], v50 offset:31232
    s_add_u32 m0, s82, 0x9000
    s_mul_i32 s98, s35, 0x700
    s_add_u32 s98, s98, s46
    buffer_load_dwordx4 v26, s[60:63], s98 offen lds
    s_lshl_b32 s6, s85, 6
    v_xor_b32 v42, s6, v42
    v_xor_b32 v43, s6, v43
    s_waitcnt lgkmcnt(6)
    v_mfma_f32_32x32x16_bf16 v[124:139], v[180:183], a[108:111], v[124:139]
    ds_read_b64_tr_b16 v[168:169], v52 offset:30720
    ds_read_b64_tr_b16 v[170:171], v52 offset:31232
    v_xor_b32 v44, s6, v44
    v_xor_b32 v45, s6, v45
    v_xor_b32 v46, s6, v46
    v_mfma_f32_32x32x16_bf16 v[140:155], v[184:187], a[108:111], v[140:155]
    ds_read_b64_tr_b16 v[172:173], v51 offset:28672
    ds_read_b64_tr_b16 v[174:175], v51 offset:29184
    buffer_load_dwordx4 v27, s[60:63], s98 offen offset:1024 lds
    v_xor_b32 v47, s6, v47
    v_xor_b32 v48, s6, v48
    v_xor_b32 v49, s6, v49
    s_waitcnt lgkmcnt(6)
    v_mfma_f32_32x32x16_bf16 v[92:107], v[156:159], a[0:3], 0
    ds_read_b64_tr_b16 v[176:177], v53 offset:28672
    ds_read_b64_tr_b16 v[178:179], v53 offset:29184
    v_mfma_f32_32x32x16_bf16 v[108:123], v[160:163], a[0:3], 0
    ds_read_b64_tr_b16 v[180:181], v51 offset:30720
    ds_read_b64_tr_b16 v[182:183], v51 offset:31232
    buffer_load_dwordx4 v28, s[60:63], s98 offen offset:2048 lds
    s_waitcnt lgkmcnt(6)
    v_mfma_f32_32x32x16_bf16 v[92:107], v[164:167], a[4:7], v[92:107]
    ds_read_b64_tr_b16 v[184:185], v53 offset:30720
    ds_read_b64_tr_b16 v[186:187], v53 offset:31232
    s_waitcnt vmcnt(15)
    s_barrier
    v_mfma_f32_32x32x16_bf16 v[108:123], v[168:171], a[4:7], v[108:123]
    ds_read_b64_tr_b16 v[156:157], v50 offset:16384
    ds_read_b64_tr_b16 v[158:159], v50 offset:16896
    buffer_load_dwordx4 v29, s[60:63], s98 offen offset:3072 lds
    v_mul_f32 v8, 0xbfb8aa3b, v124
    v_mul_f32 v9, 0xbfb8aa3b, v125
    v_mul_f32 v10, 0xbfb8aa3b, v126
    v_mul_f32 v11, 0xbfb8aa3b, v127
    s_waitcnt lgkmcnt(6)
    v_mfma_f32_32x32x16_bf16 v[92:107], v[172:175], a[8:11], v[92:107]
    ds_read_b64_tr_b16 v[160:161], v52 offset:16384
    ds_read_b64_tr_b16 v[162:163], v52 offset:16896
    v_exp_f32 v8, v8
    v_exp_f32 v9, v9
    v_mfma_f32_32x32x16_bf16 v[108:123], v[176:179], a[8:11], v[108:123]
    ds_read_b64_tr_b16 v[164:165], v50 offset:18432
    ds_read_b64_tr_b16 v[166:167], v50 offset:18944
    s_add_u32 m0, s82, 0x1000
    s_mul_i32 s98, s36, 0x700
    s_add_u32 s98, s98, s46
    buffer_load_dwordx4 v26, s[60:63], s98 offen lds
    v_exp_f32 v10, v10
    v_exp_f32 v11, v11
    s_waitcnt lgkmcnt(6)
    v_mfma_f32_32x32x16_bf16 v[92:107], v[180:183], a[12:15], v[92:107]
    ds_read_b64_tr_b16 v[168:169], v52 offset:18432
    ds_read_b64_tr_b16 v[170:171], v52 offset:18944
    v_mul_f32 v124, v124, v140
    v_mul_f32 v125, v125, v141
    v_mul_f32 v126, v126, v142
    v_mul_f32 v127, v127, v143
    v_mfma_f32_32x32x16_bf16 v[108:123], v[184:187], a[12:15], v[108:123]
    ds_read_b64_tr_b16 v[172:173], v51 offset:16384
    ds_read_b64_tr_b16 v[174:175], v51 offset:16896
    buffer_load_dwordx4 v27, s[60:63], s98 offen offset:1024 lds
    v_fma_f32 v8, v8, v228, v228
    v_fma_f32 v9, v9, v228, v228
    v_fma_f32 v10, v10, v228, v228
    v_fma_f32 v11, v11, v228, v228
    s_waitcnt lgkmcnt(6)
    v_mfma_f32_32x32x16_bf16 v[92:107], v[156:159], a[16:19], v[92:107]
    ds_read_b64_tr_b16 v[176:177], v53 offset:16384
    ds_read_b64_tr_b16 v[178:179], v53 offset:16896
    v_rcp_f32 v8, v8
    v_rcp_f32 v9, v9
    v_mfma_f32_32x32x16_bf16 v[108:123], v[160:163], a[16:19], v[108:123]
    ds_read_b64_tr_b16 v[180:181], v51 offset:18432
    ds_read_b64_tr_b16 v[182:183], v51 offset:18944
    buffer_load_dwordx4 v28, s[60:63], s98 offen offset:2048 lds
    v_rcp_f32 v10, v10
    v_rcp_f32 v11, v11
    s_waitcnt lgkmcnt(6)
    v_mfma_f32_32x32x16_bf16 v[92:107], v[164:167], a[20:23], v[92:107]
    ds_read_b64_tr_b16 v[184:185], v53 offset:18432
    ds_read_b64_tr_b16 v[186:187], v53 offset:18944
    v_mul_f32 v124, v124, v8
    v_mul_f32 v125, v125, v9
    v_mul_f32 v126, v126, v10
    v_mul_f32 v127, v127, v11
    s_waitcnt vmcnt(15)
    s_barrier
    v_mfma_f32_32x32x16_bf16 v[108:123], v[168:171], a[20:23], v[108:123]
    ds_read_b64_tr_b16 v[156:157], v50 offset:20480
    ds_read_b64_tr_b16 v[158:159], v50 offset:20992
    buffer_load_dwordx4 v29, s[60:63], s98 offen offset:3072 lds
    v_cvt_pk_bf16_f32 v196, v124, v125
    v_cvt_pk_bf16_f32 v197, v126, v127
    v_mul_f32 v8, 0xbfb8aa3b, v128
    s_waitcnt lgkmcnt(6)
    v_mfma_f32_32x32x16_bf16 v[92:107], v[172:175], a[24:27], v[92:107]
    ds_read_b64_tr_b16 v[160:161], v52 offset:20480
    ds_read_b64_tr_b16 v[162:163], v52 offset:20992
    v_mul_f32 v9, 0xbfb8aa3b, v129
    v_mul_f32 v10, 0xbfb8aa3b, v130
    v_mul_f32 v11, 0xbfb8aa3b, v131
    v_exp_f32 v8, v8
    v_mfma_f32_32x32x16_bf16 v[108:123], v[176:179], a[24:27], v[108:123]
    ds_read_b64_tr_b16 v[164:165], v50 offset:22528
    ds_read_b64_tr_b16 v[166:167], v50 offset:23040
    s_add_u32 m0, s82, 0x6000
    s_mul_i32 s98, s22, 0x700
    s_add_u32 s98, s98, s47
    buffer_load_dwordx4 v26, s[60:63], s98 offen lds
    v_exp_f32 v9, v9
    v_exp_f32 v10, v10
    s_waitcnt lgkmcnt(6)
    v_mfma_f32_32x32x16_bf16 v[92:107], v[180:183], a[28:31], v[92:107]
    ds_read_b64_tr_b16 v[168:169], v52 offset:22528
    ds_read_b64_tr_b16 v[170:171], v52 offset:23040
    v_exp_f32 v11, v11
    v_mul_f32 v128, v128, v144
    v_mfma_f32_32x32x16_bf16 v[108:123], v[184:187], a[28:31], v[108:123]
    ds_read_b64_tr_b16 v[172:173], v51 offset:20480
    ds_read_b64_tr_b16 v[174:175], v51 offset:20992
    buffer_load_dwordx4 v27, s[60:63], s98 offen offset:1024 lds
    v_mul_f32 v129, v129, v145
    v_mul_f32 v130, v130, v146
    v_mul_f32 v131, v131, v147
    v_fma_f32 v8, v8, v228, v228
    s_waitcnt lgkmcnt(6)
    v_mfma_f32_32x32x16_bf16 v[92:107], v[156:159], a[32:35], v[92:107]
    ds_read_b64_tr_b16 v[176:177], v53 offset:20480
    ds_read_b64_tr_b16 v[178:179], v53 offset:20992
    v_fma_f32 v9, v9, v228, v228
    v_fma_f32 v10, v10, v228, v228
    v_fma_f32 v11, v11, v228, v228
    v_rcp_f32 v8, v8
    v_mfma_f32_32x32x16_bf16 v[108:123], v[160:163], a[32:35], v[108:123]
    ds_read_b64_tr_b16 v[180:181], v51 offset:22528
    ds_read_b64_tr_b16 v[182:183], v51 offset:23040
    buffer_load_dwordx4 v28, s[60:63], s98 offen offset:2048 lds
    v_rcp_f32 v9, v9
    v_rcp_f32 v10, v10
    s_waitcnt lgkmcnt(6)
    v_mfma_f32_32x32x16_bf16 v[92:107], v[164:167], a[36:39], v[92:107]
    ds_read_b64_tr_b16 v[184:185], v53 offset:22528
    ds_read_b64_tr_b16 v[186:187], v53 offset:23040
    v_rcp_f32 v11, v11
    v_mul_f32 v128, v128, v8
    s_waitcnt vmcnt(15)
    s_barrier
    v_mfma_f32_32x32x16_bf16 v[108:123], v[168:171], a[36:39], v[108:123]
    ds_read_b64_tr_b16 v[156:157], v50 offset:32768
    ds_read_b64_tr_b16 v[158:159], v50 offset:33280
    buffer_load_dwordx4 v29, s[60:63], s98 offen offset:3072 lds
    v_mul_f32 v129, v129, v9
    v_mul_f32 v130, v130, v10
    v_mul_f32 v131, v131, v11
    v_cvt_pk_bf16_f32 v198, v128, v129
    s_waitcnt lgkmcnt(6)
    v_mfma_f32_32x32x16_bf16 v[92:107], v[172:175], a[40:43], v[92:107]
    ds_read_b64_tr_b16 v[160:161], v52 offset:32768
    ds_read_b64_tr_b16 v[162:163], v52 offset:33280
    v_cvt_pk_bf16_f32 v199, v130, v131
    v_mul_f32 v8, 0xbfb8aa3b, v132
    v_mul_f32 v9, 0xbfb8aa3b, v133
    v_mfma_f32_32x32x16_bf16 v[108:123], v[176:179], a[40:43], v[108:123]
    ds_read_b64_tr_b16 v[164:165], v50 offset:34816
    ds_read_b64_tr_b16 v[166:167], v50 offset:35328
    s_add_u32 m0, s82, 0x2000
    s_mul_i32 s98, s23, 0x700
    s_add_u32 s98, s98, s47
    buffer_load_dwordx4 v26, s[60:63], s98 offen lds
    v_mul_f32 v10, 0xbfb8aa3b, v134
    v_mul_f32 v11, 0xbfb8aa3b, v135
    v_exp_f32 v8, v8
    s_waitcnt lgkmcnt(6)
    v_mfma_f32_32x32x16_bf16 v[92:107], v[180:183], a[44:47], v[92:107]
    ds_read_b64_tr_b16 v[168:169], v52 offset:34816
    ds_read_b64_tr_b16 v[170:171], v52 offset:35328
    v_exp_f32 v9, v9
    v_exp_f32 v10, v10
    buffer_load_dwordx4 v[232:235], v227, s[64:67], 0 offen sc1
    v_mfma_f32_32x32x16_bf16 v[108:123], v[184:187], a[44:47], v[108:123]
    ds_read_b64_tr_b16 v[172:173], v51 offset:32768
    ds_read_b64_tr_b16 v[174:175], v51 offset:33280
    buffer_load_dwordx4 v27, s[60:63], s98 offen offset:1024 lds
    v_exp_f32 v11, v11
    v_mul_f32 v132, v132, v148
    v_mul_f32 v133, v133, v149
    s_waitcnt lgkmcnt(6)
    v_mfma_f32_32x32x16_bf16 v[92:107], v[156:159], a[48:51], v[92:107]
    ds_read_b64_tr_b16 v[176:177], v53 offset:32768
    ds_read_b64_tr_b16 v[178:179], v53 offset:33280
    v_mul_f32 v134, v134, v150
    v_mul_f32 v135, v135, v151
    v_fma_f32 v8, v8, v228, v228
    v_fma_f32 v9, v9, v228, v228
    v_mfma_f32_32x32x16_bf16 v[108:123], v[160:163], a[48:51], v[108:123]
    ds_read_b64_tr_b16 v[180:181], v51 offset:34816
    ds_read_b64_tr_b16 v[182:183], v51 offset:35328
    buffer_load_dwordx4 v28, s[60:63], s98 offen offset:2048 lds
    v_fma_f32 v10, v10, v228, v228
    v_fma_f32 v11, v11, v228, v228
    v_rcp_f32 v8, v8
    s_waitcnt lgkmcnt(6)
    v_mfma_f32_32x32x16_bf16 v[92:107], v[164:167], a[52:55], v[92:107]
    ds_read_b64_tr_b16 v[184:185], v53 offset:34816
    ds_read_b64_tr_b16 v[186:187], v53 offset:35328
    v_rcp_f32 v9, v9
    v_rcp_f32 v10, v10
    s_waitcnt vmcnt(16)
    s_barrier
    v_mfma_f32_32x32x16_bf16 v[108:123], v[168:171], a[52:55], v[108:123]
    ds_read_b64_tr_b16 v[156:157], v50
    ds_read_b64_tr_b16 v[158:159], v50 offset:512
    buffer_load_dwordx4 v29, s[60:63], s98 offen offset:3072 lds
    v_rcp_f32 v11, v11
    v_mul_f32 v132, v132, v8
    v_mul_f32 v133, v133, v9
    s_waitcnt lgkmcnt(6)
    v_mfma_f32_32x32x16_bf16 v[92:107], v[172:175], a[56:59], v[92:107]
    ds_read_b64_tr_b16 v[160:161], v52
    ds_read_b64_tr_b16 v[162:163], v52 offset:512
    v_mul_f32 v134, v134, v10
    v_mul_f32 v135, v135, v11
    v_cvt_pk_bf16_f32 v200, v132, v133
    v_cvt_pk_bf16_f32 v201, v134, v135
    v_mfma_f32_32x32x16_bf16 v[108:123], v[176:179], a[56:59], v[108:123]
    ds_read_b64_tr_b16 v[164:165], v50 offset:2048
    ds_read_b64_tr_b16 v[166:167], v50 offset:2560
    s_add_u32 m0, s82, 0x3000
    s_mul_i32 s98, s24, 0x700
    s_add_u32 s98, s98, s47
    buffer_load_dwordx4 v26, s[60:63], s98 offen lds
    v_mul_f32 v8, 0xbfb8aa3b, v136
    v_mul_f32 v9, 0xbfb8aa3b, v137
    v_mul_f32 v10, 0xbfb8aa3b, v138
    s_waitcnt lgkmcnt(6)
    v_mfma_f32_32x32x16_bf16 v[92:107], v[180:183], a[60:63], v[92:107]
    ds_read_b64_tr_b16 v[168:169], v52 offset:2048
    ds_read_b64_tr_b16 v[170:171], v52 offset:2560
    v_mul_f32 v11, 0xbfb8aa3b, v139
    v_exp_f32 v8, v8
    v_exp_f32 v9, v9
    v_mfma_f32_32x32x16_bf16 v[108:123], v[184:187], a[60:63], v[108:123]
    ds_read_b64_tr_b16 v[172:173], v51
    ds_read_b64_tr_b16 v[174:175], v51 offset:512
    buffer_load_dwordx4 v27, s[60:63], s98 offen offset:1024 lds
    v_exp_f32 v10, v10
    v_exp_f32 v11, v11
    s_waitcnt lgkmcnt(6)
    v_mfma_f32_32x32x16_bf16 v[92:107], v[156:159], a[64:67], v[92:107]
    ds_read_b64_tr_b16 v[176:177], v53
    ds_read_b64_tr_b16 v[178:179], v53 offset:512
    v_mul_f32 v136, v136, v152
    v_mul_f32 v137, v137, v153
    v_mul_f32 v138, v138, v154
    v_mfma_f32_32x32x16_bf16 v[108:123], v[160:163], a[64:67], v[108:123]
    ds_read_b64_tr_b16 v[180:181], v51 offset:2048
    ds_read_b64_tr_b16 v[182:183], v51 offset:2560
    buffer_load_dwordx4 v28, s[60:63], s98 offen offset:2048 lds
    v_mul_f32 v139, v139, v155
    v_fma_f32 v8, v8, v228, v228
    v_fma_f32 v9, v9, v228, v228
    v_fma_f32 v10, v10, v228, v228
    s_waitcnt lgkmcnt(6)
    v_mfma_f32_32x32x16_bf16 v[92:107], v[164:167], a[68:71], v[92:107]
    ds_read_b64_tr_b16 v[184:185], v53 offset:2048
    ds_read_b64_tr_b16 v[186:187], v53 offset:2560
    v_fma_f32 v11, v11, v228, v228
    v_rcp_f32 v8, v8
    v_rcp_f32 v9, v9
    s_waitcnt vmcnt(16)
    s_barrier
    v_mfma_f32_32x32x16_bf16 v[108:123], v[168:171], a[68:71], v[108:123]
    ds_read_b64_tr_b16 v[156:157], v50 offset:36864
    ds_read_b64_tr_b16 v[158:159], v50 offset:37376
    buffer_load_dwordx4 v29, s[60:63], s98 offen offset:3072 lds
    v_rcp_f32 v10, v10
    v_rcp_f32 v11, v11
    s_waitcnt lgkmcnt(6)
    v_mfma_f32_32x32x16_bf16 v[92:107], v[172:175], a[72:75], v[92:107]
    ds_read_b64_tr_b16 v[160:161], v52 offset:36864
    ds_read_b64_tr_b16 v[162:163], v52 offset:37376
    v_mul_f32 v136, v136, v8
    v_mul_f32 v137, v137, v9
    v_mul_f32 v138, v138, v10
    v_mfma_f32_32x32x16_bf16 v[108:123], v[176:179], a[72:75], v[108:123]
    ds_read_b64_tr_b16 v[164:165], v50 offset:38912
    ds_read_b64_tr_b16 v[166:167], v50 offset:39424
    s_add_u32 m0, s82, 0x7000
    s_mul_i32 s98, s25, 0x700
    s_add_u32 s98, s98, s47
    buffer_load_dwordx4 v26, s[60:63], s98 offen lds
    v_mul_f32 v139, v139, v11
    v_cvt_pk_bf16_f32 v202, v136, v137
    v_cvt_pk_bf16_f32 v203, v138, v139
    s_waitcnt lgkmcnt(6)
    v_mfma_f32_32x32x16_bf16 v[92:107], v[180:183], a[76:79], v[92:107]
    ds_read_b64_tr_b16 v[168:169], v52 offset:38912
    ds_read_b64_tr_b16 v[170:171], v52 offset:39424
    s_waitcnt vmcnt(8)
    v_cmp_ne_u32 vcc, s83, v233
    v_cmp_ne_u32 s[12:13], s83, v235
    s_nop 0
    s_or_b64 vcc, vcc, s[12:13]
    s_nop 0
    s_cmp_lg_u64 vcc, 0
    s_cbranch_scc1 SPIN_3
RES_4:
    v_fma_f32 v233, v221, v232, v223
    v_fma_f32 v235, v221, v234, v224
    v_fma_f32 v233, -v222, v234, v233
    v_fmac_f32 v235, v222, v232
    v_cmp_lt_u32 vcc, 31, v1
    s_nop 1
    v_cndmask_b32 v232, v232, v233, vcc
    v_cndmask_b32 v234, v234, v235, vcc
    v_mfma_f32_32x32x16_bf16 v[108:123], v[184:187], a[76:79], v[108:123]
    ds_read_b64_tr_b16 v[172:173], v51 offset:36864
    ds_read_b64_tr_b16 v[174:175], v51 offset:37376
    buffer_load_dwordx4 v27, s[60:63], s98 offen offset:1024 lds
    v_fmac_f32 v60, v34, v232
    v_fmac_f32 v76, v34, v234
    v_fmac_f32 v60, v220, v234
    v_fmac_f32 v76, v35, v232
    s_waitcnt lgkmcnt(6)
    v_mfma_f32_32x32x16_bf16 v[92:107], v[156:159], a[80:83], v[92:107]
    ds_read_b64_tr_b16 v[176:177], v53 offset:36864
    ds_read_b64_tr_b16 v[178:179], v53 offset:37376
    v_fmac_f32 v61, v34, v60
    v_fmac_f32 v77, v34, v76
    v_fmac_f32 v61, v220, v76
    v_mfma_f32_32x32x16_bf16 v[108:123], v[160:163], a[80:83], v[108:123]
    ds_read_b64_tr_b16 v[180:181], v51 offset:38912
    ds_read_b64_tr_b16 v[182:183], v51 offset:39424
    buffer_load_dwordx4 v28, s[60:63], s98 offen offset:2048 lds
    v_fmac_f32 v77, v35, v60
    v_fmac_f32 v62, v34, v61
    v_fmac_f32 v78, v34, v77
    s_waitcnt lgkmcnt(6)
    v_mfma_f32_32x32x16_bf16 v[92:107], v[164:167], a[84:87], v[92:107]
    ds_read_b64_tr_b16 v[184:185], v53 offset:38912
    ds_read_b64_tr_b16 v[186:187], v53 offset:39424
    v_fmac_f32 v62, v220, v77
    v_fmac_f32 v78, v35, v61
    v_fmac_f32 v63, v34, v62
    s_barrier
    v_mfma_f32_32x32x16_bf16 v[108:123], v[168:171], a[84:87], v[108:123]
    ds_read_b64_tr_b16 v[156:157], v50 offset:4096
    ds_read_b64_tr_b16 v[158:159], v50 offset:4608
    buffer_load_dwordx4 v29, s[60:63], s98 offen offset:3072 lds
    v_fmac_f32 v79, v34, v78
    v_fmac_f32 v63, v220, v78
    v_fmac_f32 v79, v35, v62
    s_waitcnt lgkmcnt(6)
    v_mfma_f32_32x32x16_bf16 v[92:107], v[172:175], a[88:91], v[92:107]
    ds_read_b64_tr_b16 v[160:161], v52 offset:4096
    ds_read_b64_tr_b16 v[162:163], v52 offset:4608
    v_fmac_f32 v64, v34, v63
    v_fmac_f32 v80, v34, v79
    v_fmac_f32 v64, v220, v79
    v_fmac_f32 v80, v35, v63
    v_mfma_f32_32x32x16_bf16 v[108:123], v[176:179], a[88:91], v[108:123]
    ds_read_b64_tr_b16 v[164:165], v50 offset:6144
    ds_read_b64_tr_b16 v[166:167], v50 offset:6656
    s_add_u32 m0, s82, 0x4000
    s_mul_i32 s98, s34, 0x700
    s_add_u32 s98, s98, s47
    buffer_load_dwordx4 v26, s[60:63], s98 offen lds
    v_fmac_f32 v65, v34, v64
    v_fmac_f32 v81, v34, v80
    v_fmac_f32 v65, v220, v80
    s_waitcnt lgkmcnt(6)
    v_mfma_f32_32x32x16_bf16 v[92:107], v[180:183], a[92:95], v[92:107]
    ds_read_b64_tr_b16 v[168:169], v52 offset:6144
    ds_read_b64_tr_b16 v[170:171], v52 offset:6656
    v_fmac_f32 v81, v35, v64
    v_fmac_f32 v66, v34, v65
    v_fmac_f32 v82, v34, v81
    v_mfma_f32_32x32x16_bf16 v[108:123], v[184:187], a[92:95], v[108:123]
    ds_read_b64_tr_b16 v[172:173], v51 offset:4096
    ds_read_b64_tr_b16 v[174:175], v51 offset:4608
    buffer_load_dwordx4 v27, s[60:63], s98 offen offset:1024 lds
    v_fmac_f32 v66, v220, v81
    v_fmac_f32 v82, v35, v65
    v_fmac_f32 v67, v34, v66
    s_waitcnt lgkmcnt(6)
    v_mfma_f32_32x32x16_bf16 v[92:107], v[156:159], a[96:99], v[92:107]
    ds_read_b64_tr_b16 v[176:177], v53 offset:4096
    ds_read_b64_tr_b16 v[178:179], v53 offset:4608
    v_fmac_f32 v83, v34, v82
    v_fmac_f32 v67, v220, v82
    v_fmac_f32 v83, v35, v66
    v_mfma_f32_32x32x16_bf16 v[108:123], v[160:163], a[96:99], v[108:123]
    ds_read_b64_tr_b16 v[180:181], v51 offset:6144
    ds_read_b64_tr_b16 v[182:183], v51 offset:6656
    buffer_load_dwordx4 v28, s[60:63], s98 offen offset:2048 lds
    v_fmac_f32 v68, v34, v67
    v_fmac_f32 v84, v34, v83
    v_fmac_f32 v68, v220, v83
    v_fmac_f32 v84, v35, v67
    s_waitcnt lgkmcnt(6)
    v_mfma_f32_32x32x16_bf16 v[92:107], v[164:167], a[100:103], v[92:107]
    ds_read_b64_tr_b16 v[184:185], v53 offset:6144
    ds_read_b64_tr_b16 v[186:187], v53 offset:6656
    v_fmac_f32 v69, v34, v68
    v_fmac_f32 v85, v34, v84
    v_fmac_f32 v69, v220, v84
    s_barrier
    v_mfma_f32_32x32x16_bf16 v[108:123], v[168:171], a[100:103], v[108:123]
    ds_read_b64_tr_b16 v[156:157], v50 offset:24576
    ds_read_b64_tr_b16 v[158:159], v50 offset:25088
    buffer_load_dwordx4 v29, s[60:63], s98 offen offset:3072 lds
    v_fmac_f32 v85, v35, v68
    v_fmac_f32 v70, v34, v69
    v_fmac_f32 v86, v34, v85
    s_waitcnt lgkmcnt(6)
    v_mfma_f32_32x32x16_bf16 v[92:107], v[172:175], a[104:107], v[92:107]
    ds_read_b64_tr_b16 v[160:161], v52 offset:24576
    ds_read_b64_tr_b16 v[162:163], v52 offset:25088
    v_fmac_f32 v70, v220, v85
    v_fmac_f32 v86, v35, v69
    v_fmac_f32 v71, v34, v70
    v_mfma_f32_32x32x16_bf16 v[108:123], v[176:179], a[104:107], v[108:123]
    ds_read_b64_tr_b16 v[164:165], v50 offset:26624
    ds_read_b64_tr_b16 v[166:167], v50 offset:27136
    s_add_u32 m0, s82, 0x5000
    s_mul_i32 s98, s35, 0x700
    s_add_u32 s98, s98, s47
    buffer_load_dwordx4 v26, s[60:63], s98 offen lds
    v_fmac_f32 v87, v34, v86
    v_fmac_f32 v71, v220, v86
    v_fmac_f32 v87, v35, v70
    s_waitcnt lgkmcnt(6)
    v_mfma_f32_32x32x16_bf16 v[92:107], v[180:183], a[108:111], v[92:107]
    ds_read_b64_tr_b16 v[168:169], v52 offset:26624
    ds_read_b64_tr_b16 v[170:171], v52 offset:27136
    v_fmac_f32 v72, v34, v71
    v_fmac_f32 v88, v34, v87
    v_fmac_f32 v72, v220, v87
    v_fmac_f32 v88, v35, v71
    v_mfma_f32_32x32x16_bf16 v[108:123], v[184:187], a[108:111], v[108:123]
    ds_read_b64_tr_b16 v[172:173], v51 offset:24576
    ds_read_b64_tr_b16 v[174:175], v51 offset:25088
    buffer_load_dwordx4 v27, s[60:63], s98 offen offset:1024 lds
    v_fmac_f32 v73, v34, v72
    v_fmac_f32 v89, v34, v88
    v_fmac_f32 v73, v220, v88
    s_waitcnt lgkmcnt(6)
    v_mfma_f32_32x32x16_bf16 v[124:139], v[156:159], a[0:3], 0
    ds_read_b64_tr_b16 v[176:177], v53 offset:24576
    ds_read_b64_tr_b16 v[178:179], v53 offset:25088
    v_fmac_f32 v89, v35, v72
    v_fmac_f32 v74, v34, v73
    v_fmac_f32 v90, v34, v89
    v_mfma_f32_32x32x16_bf16 v[140:155], v[160:163], a[0:3], 0
    ds_read_b64_tr_b16 v[180:181], v51 offset:26624
    ds_read_b64_tr_b16 v[182:183], v51 offset:27136
    buffer_load_dwordx4 v28, s[60:63], s98 offen offset:2048 lds
    v_fmac_f32 v74, v220, v89
    v_fmac_f32 v90, v35, v73
    v_fmac_f32 v75, v34, v74
    s_waitcnt lgkmcnt(6)
    v_mfma_f32_32x32x16_bf16 v[124:139], v[164:167], a[4:7], v[124:139]
    ds_read_b64_tr_b16 v[184:185], v53 offset:26624
    ds_read_b64_tr_b16 v[186:187], v53 offset:27136
    v_fmac_f32 v91, v34, v90
    v_fmac_f32 v75, v220, v90
    v_fmac_f32 v91, v35, v74
    s_waitcnt vmcnt(15)
    s_barrier
    v_mfma_f32_32x32x16_bf16 v[140:155], v[168:171], a[4:7], v[140:155]
    ds_read_b64_tr_b16 v[156:157], v50 offset:8192
    ds_read_b64_tr_b16 v[158:159], v50 offset:8704
    buffer_load_dwordx4 v29, s[60:63], s98 offen offset:3072 lds
    v_mul_f32 v8, 0xbfb8aa3b, v92
    v_mul_f32 v9, 0xbfb8aa3b, v93
    v_mul_f32 v10, 0xbfb8aa3b, v94
    v_mul_f32 v11, 0xbfb8aa3b, v95
    v_exp_f32 v8, v8
    s_waitcnt lgkmcnt(6)
    v_mfma_f32_32x32x16_bf16 v[124:139], v[172:175], a[8:11], v[124:139]
    ds_read_b64_tr_b16 v[160:161], v52 offset:8192
    ds_read_b64_tr_b16 v[162:163], v52 offset:8704
    v_exp_f32 v9, v9
    v_exp_f32 v10, v10
    v_mfma_f32_32x32x16_bf16 v[140:155], v[176:179], a[8:11], v[140:155]
    ds_read_b64_tr_b16 v[164:165], v50 offset:10240
    ds_read_b64_tr_b16 v[166:167], v50 offset:10752
    s_add_u32 m0, s82, 0
    s_mul_i32 s98, s36, 0x700
    s_add_u32 s98, s98, s47
    buffer_load_dwordx4 v26, s[60:63], s98 offen lds
    v_exp_f32 v11, v11
    v_mul_f32 v92, v92, v108
    v_mul_f32 v93, v93, v109
    s_waitcnt lgkmcnt(6)
    v_mfma_f32_32x32x16_bf16 v[124:139], v[180:183], a[12:15], v[124:139]
    ds_read_b64_tr_b16 v[168:169], v52 offset:10240
    ds_read_b64_tr_b16 v[170:171], v52 offset:10752
    v_mul_f32 v94, v94, v110
    v_mul_f32 v95, v95, v111
    v_fma_f32 v8, v8, v228, v228
    v_fma_f32 v9, v9, v228, v228
    v_mfma_f32_32x32x16_bf16 v[140:155], v[184:187], a[12:15], v[140:155]
    ds_read_b64_tr_b16 v[172:173], v51 offset:8192
    ds_read_b64_tr_b16 v[174:175], v51 offset:8704
    buffer_load_dwordx4 v27, s[60:63], s98 offen offset:1024 lds
    v_fma_f32 v10, v10, v228, v228
    v_fma_f32 v11, v11, v228, v228
    v_rcp_f32 v8, v8
    v_rcp_f32 v9, v9
    s_waitcnt lgkmcnt(6)
    v_mfma_f32_32x32x16_bf16 v[124:139], v[156:159], a[16:19], v[124:139]
    ds_read_b64_tr_b16 v[176:177], v53 offset:8192
    ds_read_b64_tr_b16 v[178:179], v53 offset:8704
    v_rcp_f32 v10, v10
    v_rcp_f32 v11, v11
    v_mfma_f32_32x32x16_bf16 v[140:155], v[160:163], a[16:19], v[140:155]
    ds_read_b64_tr_b16 v[180:181], v51 offset:10240
    ds_read_b64_tr_b16 v[182:183], v51 offset:10752
    buffer_load_dwordx4 v28, s[60:63], s98 offen offset:2048 lds
    v_mul_f32 v92, v92, v8
    v_mul_f32 v93, v93, v9
    v_mul_f32 v94, v94, v10
    v_mul_f32 v95, v95, v11
    s_waitcnt lgkmcnt(6)
    v_mfma_f32_32x32x16_bf16 v[124:139], v[164:167], a[20:23], v[124:139]
    ds_read_b64_tr_b16 v[184:185], v53 offset:10240
    ds_read_b64_tr_b16 v[186:187], v53 offset:10752
    v_cvt_pk_bf16_f32 v204, v92, v93
    v_cvt_pk_bf16_f32 v205, v94, v95
    v_mul_f32 v8, 0xbfb8aa3b, v96
    v_mul_f32 v9, 0xbfb8aa3b, v97
    s_waitcnt vmcnt(15)
    s_barrier
    v_mfma_f32_32x32x16_bf16 v[140:155], v[168:171], a[20:23], v[140:155]
    ds_read_b64_tr_b16 v[156:157], v50 offset:12288
    ds_read_b64_tr_b16 v[158:159], v50 offset:12800
    buffer_load_dwordx4 v29, s[60:63], s98 offen offset:3072 lds
    v_mul_f32 v10, 0xbfb8aa3b, v98
    v_mul_f32 v11, 0xbfb8aa3b, v99
    v_exp_f32 v8, v8
    v_exp_f32 v9, v9
    s_waitcnt lgkmcnt(6)
    v_mfma_f32_32x32x16_bf16 v[124:139], v[172:175], a[24:27], v[124:139]
    ds_read_b64_tr_b16 v[160:161], v52 offset:12288
    ds_read_b64_tr_b16 v[162:163], v52 offset:12800
    v_exp_f32 v10, v10
    v_exp_f32 v11, v11
    v_mfma_f32_32x32x16_bf16 v[140:155], v[176:179], a[24:27], v[140:155]
    ds_read_b64_tr_b16 v[164:165], v50 offset:14336
    ds_read_b64_tr_b16 v[166:167], v50 offset:14848
    s_add_u32 m0, s82, 0x1000
    s_add_u32 s98, s26, s40
    buffer_load_dwordx4 v30, s[88:91], s98 offen lds
    v_mul_f32 v96, v96, v112
    v_mul_f32 v97, v97, v113
    v_mul_f32 v98, v98, v114
    v_mul_f32 v99, v99, v115
    s_waitcnt lgkmcnt(6)
    v_mfma_f32_32x32x16_bf16 v[124:139], v[180:183], a[28:31], v[124:139]
    ds_read_b64_tr_b16 v[168:169], v52 offset:14336
    ds_read_b64_tr_b16 v[170:171], v52 offset:14848
    v_fma_f32 v8, v8, v228, v228
    v_fma_f32 v9, v9, v228, v228
    v_fma_f32 v10, v10, v228, v228
    v_fma_f32 v11, v11, v228, v228
    v_mfma_f32_32x32x16_bf16 v[140:155], v[184:187], a[28:31], v[140:155]
    ds_read_b64_tr_b16 v[172:173], v51 offset:12288
    ds_read_b64_tr_b16 v[174:175], v51 offset:12800
    buffer_load_dwordx4 v31, s[88:91], s98 offen offset:1024 lds
    v_rcp_f32 v8, v8
    v_rcp_f32 v9, v9
    v_rcp_f32 v10, v10
    s_waitcnt lgkmcnt(6)
    v_mfma_f32_32x32x16_bf16 v[124:139], v[156:159], a[32:35], v[124:139]
    ds_read_b64_tr_b16 v[176:177], v53 offset:12288
    ds_read_b64_tr_b16 v[178:179], v53 offset:12800
    v_rcp_f32 v11, v11
    v_mul_f32 v96, v96, v8
    v_mfma_f32_32x32x16_bf16 v[140:155], v[160:163], a[32:35], v[140:155]
    ds_read_b64_tr_b16 v[180:181], v51 offset:14336
    ds_read_b64_tr_b16 v[182:183], v51 offset:14848
    buffer_load_dwordx4 v32, s[88:91], s98 offen offset:2048 lds
    v_mul_f32 v97, v97, v9
    v_mul_f32 v98, v98, v10
    v_mul_f32 v99, v99, v11
    v_cvt_pk_bf16_f32 v206, v96, v97
    v_cvt_pk_bf16_f32 v207, v98, v99
    s_waitcnt lgkmcnt(6)
    v_mfma_f32_32x32x16_bf16 v[124:139], v[164:167], a[36:39], v[124:139]
    ds_read_b64_tr_b16 v[184:185], v53 offset:14336
    ds_read_b64_tr_b16 v[186:187], v53 offset:14848
    v_mul_f32 v8, 0xbfb8aa3b, v100
    v_mul_f32 v9, 0xbfb8aa3b, v101
    v_mul_f32 v10, 0xbfb8aa3b, v102
    v_mul_f32 v11, 0xbfb8aa3b, v103
    s_waitcnt vmcnt(15)
    s_barrier
    v_mfma_f32_32x32x16_bf16 v[140:155], v[168:171], a[36:39], v[140:155]
    ds_read_b64_tr_b16 v[156:157], v50 offset:28672
    ds_read_b64_tr_b16 v[158:159], v50 offset:29184
    buffer_load_dwordx4 v33, s[88:91], s98 offen offset:3072 lds
    v_exp_f32 v8, v8
    v_exp_f32 v9, v9
    v_exp_f32 v10, v10
    s_waitcnt lgkmcnt(6)
    v_mfma_f32_32x32x16_bf16 v[124:139], v[172:175], a[40:43], v[124:139]
    ds_read_b64_tr_b16 v[160:161], v52 offset:28672
    ds_read_b64_tr_b16 v[162:163], v52 offset:29184
    v_exp_f32 v11, v11
    v_mul_f32 v100, v100, v116
    v_mfma_f32_32x32x16_bf16 v[140:155], v[176:179], a[40:43], v[140:155]
    ds_read_b64_tr_b16 v[164:165], v50 offset:30720
    ds_read_b64_tr_b16 v[166:167], v50 offset:31232
    s_add_u32 m0, s82, 0x6000
    s_add_u32 s98, s26, s41
    buffer_load_dwordx4 v30, s[88:91], s98 offen lds
    v_mul_f32 v101, v101, v117
    v_mul_f32 v102, v102, v118
    v_mul_f32 v103, v103, v119
    v_fma_f32 v8, v8, v228, v228
    v_fma_f32 v9, v9, v228, v228
    s_waitcnt lgkmcnt(6)
    v_mfma_f32_32x32x16_bf16 v[124:139], v[180:183], a[44:47], v[124:139]
    ds_read_b64_tr_b16 v[168:169], v52 offset:30720
    ds_read_b64_tr_b16 v[170:171], v52 offset:31232
    v_fma_f32 v10, v10, v228, v228
    v_fma_f32 v11, v11, v228, v228
    v_rcp_f32 v8, v8
    v_mfma_f32_32x32x16_bf16 v[140:155], v[184:187], a[44:47], v[140:155]
    ds_read_b64_tr_b16 v[172:173], v51 offset:28672
    ds_read_b64_tr_b16 v[174:175], v51 offset:29184
    buffer_load_dwordx4 v31, s[88:91], s98 offen offset:1024 lds
    v_rcp_f32 v9, v9
    v_rcp_f32 v10, v10
    v_rcp_f32 v11, v11
    s_waitcnt lgkmcnt(6)
    v_mfma_f32_32x32x16_bf16 v[124:139], v[156:159], a[48:51], v[124:139]
    ds_read_b64_tr_b16 v[176:177], v53 offset:28672
    ds_read_b64_tr_b16 v[178:179], v53 offset:29184
    v_mul_f32 v100, v100, v8
    v_mul_f32 v101, v101, v9
    v_mul_f32 v102, v102, v10
    v_mfma_f32_32x32x16_bf16 v[140:155], v[160:163], a[48:51], v[140:155]
    ds_read_b64_tr_b16 v[180:181], v51 offset:30720
    ds_read_b64_tr_b16 v[182:183], v51 offset:31232
    buffer_load_dwordx4 v32, s[88:91], s98 offen offset:2048 lds
    v_mul_f32 v103, v103, v11
    v_cvt_pk_bf16_f32 v208, v100, v101
    v_cvt_pk_bf16_f32 v209, v102, v103
    v_mul_f32 v8, 0xbfb8aa3b, v104
    v_mul_f32 v9, 0xbfb8aa3b, v105
    s_waitcnt lgkmcnt(6)
    v_mfma_f32_32x32x16_bf16 v[124:139], v[164:167], a[52:55], v[124:139]
    ds_read_b64_tr_b16 v[184:185], v53 offset:30720
    ds_read_b64_tr_b16 v[186:187], v53 offset:31232
    v_mul_f32 v10, 0xbfb8aa3b, v106
    v_mul_f32 v11, 0xbfb8aa3b, v107
    v_exp_f32 v8, v8
    s_waitcnt vmcnt(15)
    s_barrier
    v_mfma_f32_32x32x16_bf16 v[140:155], v[168:171], a[52:55], v[140:155]
    ds_read_b64_tr_b16 v[156:157], v50 offset:16384
    ds_read_b64_tr_b16 v[158:159], v50 offset:16896
    buffer_load_dwordx4 v33, s[88:91], s98 offen offset:3072 lds
    v_exp_f32 v9, v9
    v_exp_f32 v10, v10
    v_exp_f32 v11, v11
    s_waitcnt lgkmcnt(6)
    v_mfma_f32_32x32x16_bf16 v[124:139], v[172:175], a[56:59], v[124:139]
    ds_read_b64_tr_b16 v[160:161], v52 offset:16384
    ds_read_b64_tr_b16 v[162:163], v52 offset:16896
    v_mul_f32 v104, v104, v120
    v_mul_f32 v105, v105, v121
    v_mul_f32 v106, v106, v122
    v_mfma_f32_32x32x16_bf16 v[140:155], v[176:179], a[56:59], v[140:155]
    ds_read_b64_tr_b16 v[164:165], v50 offset:18432
    ds_read_b64_tr_b16 v[166:167], v50 offset:18944
    s_add_u32 m0, s82, 0x2000
    s_mul_i32 s98, s26, 0x1c0
    buffer_load_dwordx4 v22, s[68:71], s98 offen lds
    v_mul_f32 v107, v107, v123
    v_fma_f32 v8, v8, v228, v228
    v_fma_f32 v9, v9, v228, v228
    v_fma_f32 v10, v10, v228, v228
    v_fma_f32 v11, v11, v228, v228
    s_waitcnt lgkmcnt(6)
    v_mfma_f32_32x32x16_bf16 v[124:139], v[180:183], a[60:63], v[124:139]
    ds_read_b64_tr_b16 v[168:169], v52 offset:18432
    ds_read_b64_tr_b16 v[170:171], v52 offset:18944
    v_rcp_f32 v8, v8
    v_rcp_f32 v9, v9
    v_mfma_f32_32x32x16_bf16 v[140:155], v[184:187], a[60:63], v[140:155]
    ds_read_b64_tr_b16 v[172:173], v51 offset:16384
    ds_read_b64_tr_b16 v[174:175], v51 offset:16896
    buffer_load_dwordx4 v23, s[68:71], s98 offen offset:1024 lds
    v_rcp_f32 v10, v10
    v_rcp_f32 v11, v11
    v_mul_f32 v104, v104, v8
    s_waitcnt lgkmcnt(6)
    v_mfma_f32_32x32x16_bf16 v[124:139], v[156:159], a[64:67], v[124:139]
    ds_read_b64_tr_b16 v[176:177], v53 offset:16384
    ds_read_b64_tr_b16 v[178:179], v53 offset:16896
    v_mul_f32 v105, v105, v9
    v_mul_f32 v106, v106, v10
    v_mul_f32 v107, v107, v11
    v_cvt_pk_bf16_f32 v210, v104, v105
    v_mfma_f32_32x32x16_bf16 v[140:155], v[160:163], a[64:67], v[140:155]
    ds_read_b64_tr_b16 v[180:181], v51 offset:18432
    ds_read_b64_tr_b16 v[182:183], v51 offset:18944
    buffer_load_dwordx4 v24, s[68:71], s98 offen offset:2048 lds
    v_cvt_pk_bf16_f32 v211, v106, v107
    v_mul_f32_dpp v60, v230, v60 row_newbcast:0 row_mask:0xf bank_mask:0xf
    v_mul_f32_dpp v61, v230, v61 row_newbcast:1 row_mask:0xf bank_mask:0xf
    v_mul_f32_dpp v62, v230, v62 row_newbcast:2 row_mask:0xf bank_mask:0xf
    v_mul_f32_dpp v63, v230, v63 row_newbcast:3 row_mask:0xf bank_mask:0xf
    s_waitcnt lgkmcnt(6)
    v_mfma_f32_32x32x16_bf16 v[124:139], v[164:167], a[68:71], v[124:139]
    ds_read_b64_tr_b16 v[184:185], v53 offset:18432
    ds_read_b64_tr_b16 v[186:187], v53 offset:18944
    v_mul_f32_dpp v64, v230, v64 row_newbcast:4 row_mask:0xf bank_mask:0xf
    v_mul_f32_dpp v65, v230, v65 row_newbcast:5 row_mask:0xf bank_mask:0xf
    v_mul_f32_dpp v66, v230, v66 row_newbcast:6 row_mask:0xf bank_mask:0xf
    v_mul_f32_dpp v67, v230, v67 row_newbcast:7 row_mask:0xf bank_mask:0xf
    s_waitcnt vmcnt(15)
    s_barrier
    v_mfma_f32_32x32x16_bf16 v[140:155], v[168:171], a[68:71], v[140:155]
    ds_read_b64_tr_b16 v[156:157], v50 offset:20480
    ds_read_b64_tr_b16 v[158:159], v50 offset:20992
    buffer_load_dwordx4 v25, s[68:71], s98 offen offset:3072 lds
    v_mul_f32_dpp v68, v230, v68 row_newbcast:8 row_mask:0xf bank_mask:0xf
    v_mul_f32_dpp v69, v230, v69 row_newbcast:9 row_mask:0xf bank_mask:0xf
    v_mul_f32_dpp v70, v230, v70 row_newbcast:10 row_mask:0xf bank_mask:0xf
    v_mul_f32_dpp v71, v230, v71 row_newbcast:11 row_mask:0xf bank_mask:0xf
    v_mul_f32_dpp v72, v230, v72 row_newbcast:12 row_mask:0xf bank_mask:0xf
    s_waitcnt lgkmcnt(6)
    v_mfma_f32_32x32x16_bf16 v[124:139], v[172:175], a[72:75], v[124:139]
    ds_read_b64_tr_b16 v[160:161], v52 offset:20480
    ds_read_b64_tr_b16 v[162:163], v52 offset:20992
    v_mul_f32_dpp v73, v230, v73 row_newbcast:13 row_mask:0xf bank_mask:0xf
    v_mul_f32_dpp v74, v230, v74 row_newbcast:14 row_mask:0xf bank_mask:0xf
    v_mul_f32_dpp v75, v230, v75 row_newbcast:15 row_mask:0xf bank_mask:0xf
    v_cvt_pk_bf16_f32 v60, v60, v61
    v_mfma_f32_32x32x16_bf16 v[140:155], v[176:179], a[72:75], v[140:155]
    ds_read_b64_tr_b16 v[164:165], v50 offset:22528
    ds_read_b64_tr_b16 v[166:167], v50 offset:23040
    v_cvt_pk_bf16_f32 v61, v62, v63
    v_cvt_pk_bf16_f32 v62, v64, v65
    v_cvt_pk_bf16_f32 v63, v66, v67
    v_cvt_pk_bf16_f32 v64, v68, v69
    v_cvt_pk_bf16_f32 v65, v70, v71
    s_waitcnt lgkmcnt(6)
    v_mfma_f32_32x32x16_bf16 v[124:139], v[180:183], a[76:79], v[124:139]
    ds_read_b64_tr_b16 v[168:169], v52 offset:22528
    ds_read_b64_tr_b16 v[170:171], v52 offset:23040
    v_cvt_pk_bf16_f32 v66, v72, v73
    v_cvt_pk_bf16_f32 v67, v74, v75
    v_mul_f32_dpp v76, v230, v76 row_newbcast:0 row_mask:0xf bank_mask:0xf
    v_mul_f32_dpp v77, v230, v77 row_newbcast:1 row_mask:0xf bank_mask:0xf
    v_mfma_f32_32x32x16_bf16 v[140:155], v[184:187], a[76:79], v[140:155]
    ds_read_b64_tr_b16 v[172:173], v51 offset:20480
    ds_read_b64_tr_b16 v[174:175], v51 offset:20992
    v_mul_f32_dpp v78, v230, v78 row_newbcast:2 row_mask:0xf bank_mask:0xf
    v_mul_f32_dpp v79, v230, v79 row_newbcast:3 row_mask:0xf bank_mask:0xf
    v_mul_f32_dpp v80, v230, v80 row_newbcast:4 row_mask:0xf bank_mask:0xf
    v_mul_f32_dpp v81, v230, v81 row_newbcast:5 row_mask:0xf bank_mask:0xf
    v_mul_f32_dpp v82, v230, v82 row_newbcast:6 row_mask:0xf bank_mask:0xf
    s_waitcnt lgkmcnt(6)
    v_mfma_f32_32x32x16_bf16 v[124:139], v[156:159], a[80:83], v[124:139]
    ds_read_b64_tr_b16 v[176:177], v53 offset:20480
    ds_read_b64_tr_b16 v[178:179], v53 offset:20992
    v_mul_f32_dpp v83, v230, v83 row_newbcast:7 row_mask:0xf bank_mask:0xf
    v_mul_f32_dpp v84, v230, v84 row_newbcast:8 row_mask:0xf bank_mask:0xf
    v_mul_f32_dpp v85, v230, v85 row_newbcast:9 row_mask:0xf bank_mask:0xf
    v_mul_f32_dpp v86, v230, v86 row_newbcast:10 row_mask:0xf bank_mask:0xf
    v_mfma_f32_32x32x16_bf16 v[140:155], v[160:163], a[80:83], v[140:155]
    ds_read_b64_tr_b16 v[180:181], v51 offset:22528
    ds_read_b64_tr_b16 v[182:183], v51 offset:23040
    v_mul_f32_dpp v87, v230, v87 row_newbcast:11 row_mask:0xf bank_mask:0xf
    v_mul_f32_dpp v88, v230, v88 row_newbcast:12 row_mask:0xf bank_mask:0xf
    v_mul_f32_dpp v89, v230, v89 row_newbcast:13 row_mask:0xf bank_mask:0xf
    v_mul_f32_dpp v90, v230, v90 row_newbcast:14 row_mask:0xf bank_mask:0xf
    v_mul_f32_dpp v91, v230, v91 row_newbcast:15 row_mask:0xf bank_mask:0xf
    s_waitcnt lgkmcnt(6)
    v_mfma_f32_32x32x16_bf16 v[124:139], v[164:167], a[84:87], v[124:139]
    ds_read_b64_tr_b16 v[184:185], v53 offset:22528
    ds_read_b64_tr_b16 v[186:187], v53 offset:23040
    v_cvt_pk_bf16_f32 v76, -v76, -v77
    v_cvt_pk_bf16_f32 v77, -v78, -v79
    v_cvt_pk_bf16_f32 v78, -v80, -v81
    v_cvt_pk_bf16_f32 v79, -v82, -v83
    s_waitcnt vmcnt(12)
    s_waitcnt vmcnt(0)
    s_barrier
    v_mfma_f32_32x32x16_bf16 v[140:155], v[168:171], a[84:87], v[140:155]
    ds_read_b64_tr_b16 v[156:157], v50
    ds_read_b64_tr_b16 v[158:159], v50 offset:512
    v_cvt_pk_bf16_f32 v80, -v84, -v85
    v_cvt_pk_bf16_f32 v81, -v86, -v87
    v_cvt_pk_bf16_f32 v82, -v88, -v89
    v_cvt_pk_bf16_f32 v83, -v90, -v91
    s_waitcnt lgkmcnt(6)
    v_mfma_f32_32x32x16_bf16 v[124:139], v[172:175], a[88:91], v[124:139]
    ds_read_b64_tr_b16 v[160:161], v52
    ds_read_b64_tr_b16 v[162:163], v52 offset:512
    v_mfma_f32_32x32x16_bf16 v[140:155], v[176:179], a[88:91], v[140:155]
    ds_read_b64_tr_b16 v[164:165], v50 offset:2048
    ds_read_b64_tr_b16 v[166:167], v50 offset:2560
    ds_write_b128 v38, v[188:191] offset:28672
    s_waitcnt lgkmcnt(7)
    v_mfma_f32_32x32x16_bf16 v[124:139], v[180:183], a[92:95], v[124:139]
    ds_read_b64_tr_b16 v[168:169], v52 offset:2048
    ds_read_b64_tr_b16 v[170:171], v52 offset:2560
    ds_write_b128 v38, v[192:195] offset:29696
    v_mfma_f32_32x32x16_bf16 v[140:155], v[184:187], a[92:95], v[140:155]
    ds_read_b64_tr_b16 v[172:173], v51
    ds_read_b64_tr_b16 v[174:175], v51 offset:512
    ds_write_b128 v38, v[196:199] offset:30720
    s_waitcnt lgkmcnt(9)
    v_mfma_f32_32x32x16_bf16 v[124:139], v[156:159], a[96:99], v[124:139]
    ds_read_b64_tr_b16 v[176:177], v53
    ds_read_b64_tr_b16 v[178:179], v53 offset:512
    ds_write_b128 v38, v[200:203] offset:31744
    v_mfma_f32_32x32x16_bf16 v[140:155], v[160:163], a[96:99], v[140:155]
    ds_read_b64_tr_b16 v[180:181], v51 offset:2048
    ds_read_b64_tr_b16 v[182:183], v51 offset:2560
    ds_write_b128 v38, v[204:207] offset:32768
    s_waitcnt lgkmcnt(10)
    v_mfma_f32_32x32x16_bf16 v[124:139], v[164:167], a[100:103], v[124:139]
    ds_read_b64_tr_b16 v[184:185], v53 offset:2048
    ds_read_b64_tr_b16 v[186:187], v53 offset:2560
    ds_write_b128 v38, v[208:211] offset:33792
    v_mfma_f32_32x32x16_bf16 v[140:155], v[168:171], a[100:103], v[140:155]
    ds_write_b128 v40, v[60:63] offset:36864
    s_waitcnt lgkmcnt(8)
    v_mfma_f32_32x32x16_bf16 v[124:139], v[172:175], a[104:107], v[124:139]
    ds_write_b128 v21, v[64:67] offset:36864
    v_mfma_f32_32x32x16_bf16 v[140:155], v[176:179], a[104:107], v[140:155]
    ds_write_b128 v40, v[76:79] offset:38912
    s_waitcnt lgkmcnt(4)
    v_mfma_f32_32x32x16_bf16 v[124:139], v[180:183], a[108:111], v[124:139]
    ds_write_b128 v21, v[80:83] offset:38912
    v_mfma_f32_32x32x16_bf16 v[140:155], v[184:187], a[108:111], v[140:155]
    s_nop 9
    v_mul_f32 v8, 0xbfb8aa3b, v124
    v_mul_f32 v9, 0xbfb8aa3b, v125
    v_mul_f32 v10, 0xbfb8aa3b, v126
    v_mul_f32 v11, 0xbfb8aa3b, v127
    v_exp_f32 v8, v8
    v_exp_f32 v9, v9
    v_exp_f32 v10, v10
    v_exp_f32 v11, v11
    v_mul_f32 v124, v124, v140
    v_mul_f32 v125, v125, v141
    v_mul_f32 v126, v126, v142
    v_mul_f32 v127, v127, v143
    v_fma_f32 v8, v8, v228, v228
    v_fma_f32 v9, v9, v228, v228
    v_fma_f32 v10, v10, v228, v228
    v_fma_f32 v11, v11, v228, v228
    v_rcp_f32 v8, v8
    v_rcp_f32 v9, v9
    v_rcp_f32 v10, v10
    v_rcp_f32 v11, v11
    v_mul_f32 v124, v124, v8
    v_mul_f32 v125, v125, v9
    v_mul_f32 v126, v126, v10
    v_mul_f32 v127, v127, v11
    v_cvt_pk_bf16_f32 v212, v124, v125
    v_cvt_pk_bf16_f32 v213, v126, v127
    v_mul_f32 v8, 0xbfb8aa3b, v128
    v_mul_f32 v9, 0xbfb8aa3b, v129
    v_mul_f32 v10, 0xbfb8aa3b, v130
    v_mul_f32 v11, 0xbfb8aa3b, v131
    v_exp_f32 v8, v8
    v_exp_f32 v9, v9
    v_exp_f32 v10, v10
    v_exp_f32 v11, v11
    v_mul_f32 v128, v128, v144
    v_mul_f32 v129, v129, v145
    v_mul_f32 v130, v130, v146
    v_mul_f32 v131, v131, v147
    v_fma_f32 v8, v8, v228, v228
    v_fma_f32 v9, v9, v228, v228
    v_fma_f32 v10, v10, v228, v228
    v_fma_f32 v11, v11, v228, v228
    v_rcp_f32 v8, v8
    v_rcp_f32 v9, v9
    v_rcp_f32 v10, v10
    v_rcp_f32 v11, v11
    v_mul_f32 v128, v128, v8
    v_mul_f32 v129, v129, v9
    v_mul_f32 v130, v130, v10
    v_mul_f32 v131, v131, v11
    v_cvt_pk_bf16_f32 v214, v128, v129
    v_cvt_pk_bf16_f32 v215, v130, v131
    v_mul_f32 v8, 0xbfb8aa3b, v132
    v_mul_f32 v9, 0xbfb8aa3b, v133
    v_mul_f32 v10, 0xbfb8aa3b, v134
    v_mul_f32 v11, 0xbfb8aa3b, v135
    v_exp_f32 v8, v8
    v_exp_f32 v9, v9
    v_exp_f32 v10, v10
    v_exp_f32 v11, v11
    ds_write_b128 v38, v[212:215] offset:34816
    v_mul_f32 v132, v132, v148
    v_mul_f32 v133, v133, v149
    v_mul_f32 v134, v134, v150
    v_mul_f32 v135, v135, v151
    v_fma_f32 v8, v8, v228, v228
    v_fma_f32 v9, v9, v228, v228
    v_fma_f32 v10, v10, v228, v228
    v_fma_f32 v11, v11, v228, v228
    v_rcp_f32 v8, v8
    v_rcp_f32 v9, v9
    v_rcp_f32 v10, v10
    v_rcp_f32 v11, v11
    v_mul_f32 v132, v132, v8
    v_mul_f32 v133, v133, v9
    v_mul_f32 v134, v134, v10
    v_mul_f32 v135, v135, v11
    v_cvt_pk_bf16_f32 v216, v132, v133
    v_cvt_pk_bf16_f32 v217, v134, v135
    v_mul_f32 v8, 0xbfb8aa3b, v136
    v_mul_f32 v9, 0xbfb8aa3b, v137
    v_mul_f32 v10, 0xbfb8aa3b, v138
    v_mul_f32 v11, 0xbfb8aa3b, v139
    v_exp_f32 v8, v8
    v_exp_f32 v9, v9
    v_exp_f32 v10, v10
    v_exp_f32 v11, v11
    v_mul_f32 v136, v136, v152
    v_mul_f32 v137, v137, v153
    v_mul_f32 v138, v138, v154
    v_mul_f32 v139, v139, v155
    v_fma_f32 v8, v8, v228, v228
    v_fma_f32 v9, v9, v228, v228
    v_fma_f32 v10, v10, v228, v228
    v_fma_f32 v11, v11, v228, v228
    v_rcp_f32 v8, v8
    v_rcp_f32 v9, v9
    v_rcp_f32 v10, v10
    v_rcp_f32 v11, v11
    v_mul_f32 v136, v136, v8
    v_mul_f32 v137, v137, v9
    v_mul_f32 v138, v138, v10
    v_mul_f32 v139, v139, v11
    v_cvt_pk_bf16_f32 v218, v136, v137
    v_cvt_pk_bf16_f32 v219, v138, v139
    ds_write_b128 v38, v[216:219] offset:35840
    ds_read_b64_tr_b16 v[156:157], v54 offset:4096
    ds_read_b64_tr_b16 v[158:159], v54 offset:5120
    ds_read_b64_tr_b16 v[160:161], v54 offset:6144
    ds_read_b64_tr_b16 v[162:163], v54 offset:7168
    ds_read_b64_tr_b16 v[164:165], v56 offset:4096
    ds_read_b64_tr_b16 v[166:167], v56 offset:5120
    ds_read_b64_tr_b16 v[168:169], v56 offset:6144
    ds_read_b64_tr_b16 v[170:171], v56 offset:7168
    ds_read_b64_tr_b16 v[172:173], v55 offset:4096
    ds_read_b64_tr_b16 v[174:175], v55 offset:5120
    s_waitcnt lgkmcnt(0)
    s_barrier
    ds_read_b128 a[112:115], v39 offset:28672
    ds_read_b128 a[116:119], v39 offset:29696
    ds_read_b128 a[120:123], v39 offset:30720
    ds_read_b128 a[124:127], v39 offset:31744
    ds_read_b128 a[128:131], v39 offset:32768
    ds_read_b128 a[132:135], v39 offset:33792
    ds_read_b128 a[136:139], v39 offset:34816
    ds_read_b128 a[140:143], v39 offset:35840
    ds_read_b64_tr_b16 a[144:145], v41 offset:36864
    ds_read_b64_tr_b16 a[146:147], v245 offset:37120
    ds_read_b64_tr_b16 a[148:149], v41 offset:37888
    ds_read_b64_tr_b16 a[150:151], v245 offset:38144
    ds_read_b64_tr_b16 a[152:153], v41 offset:38912
    ds_read_b64_tr_b16 a[154:155], v245 offset:39168
    ds_read_b64_tr_b16 a[156:157], v41 offset:39936
    ds_read_b64_tr_b16 a[158:159], v245 offset:40192
    ds_read_b64_tr_b16 a[160:161], v20 offset:36864
    ds_read_b64_tr_b16 a[162:163], v246 offset:37120
    ds_read_b64_tr_b16 a[164:165], v20 offset:37888
    ds_read_b64_tr_b16 a[166:167], v246 offset:38144
    ds_read_b64_tr_b16 a[168:169], v20 offset:38912
    ds_read_b64_tr_b16 a[170:171], v246 offset:39168
    ds_read_b64_tr_b16 a[172:173], v20 offset:39936
    ds_read_b64_tr_b16 a[174:175], v246 offset:40192
    v_mfma_f32_32x32x16_bf16 v[92:107], v[188:191], v[156:159], 0
    ds_read_b64_tr_b16 v[176:177], v55 offset:6144
    ds_read_b64_tr_b16 v[178:179], v55 offset:7168
    s_add_u32 m0, s82, 0x3000
    s_add_u32 s98, s27, s40
    buffer_load_dwordx4 v30, s[88:91], s98 offen lds
    v_mfma_f32_32x32x16_bf16 v[92:107], v[192:195], v[160:163], v[92:107]
    ds_read_b64_tr_b16 v[180:181], v57 offset:4096
    ds_read_b64_tr_b16 v[182:183], v57 offset:5120
    buffer_load_dwordx4 v31, s[88:91], s98 offen offset:1024 lds
    v_mfma_f32_32x32x16_bf16 v[92:107], v[196:199], v[164:167], v[92:107]
    ds_read_b64_tr_b16 v[184:185], v57 offset:6144
    ds_read_b64_tr_b16 v[186:187], v57 offset:7168
    buffer_load_dwordx4 v32, s[88:91], s98 offen offset:2048 lds
    global_load_ushort v238, v238, s[32:33]
    s_movk_i32 s99, 0
    s_waitcnt lgkmcnt(6)
    s_barrier
    v_mfma_f32_32x32x16_bf16 v[92:107], v[200:203], v[168:171], v[92:107]
    ds_read_b64_tr_b16 v[156:157], v54 offset:24576
    ds_read_b64_tr_b16 v[158:159], v54 offset:25600
    buffer_load_dwordx4 v33, s[88:91], s98 offen offset:3072 lds
    buffer_load_ushort v124, v237, s[52:55], s99 offen
    s_waitcnt lgkmcnt(6)
    v_mfma_f32_32x32x16_bf16 v[92:107], a[112:115], v[172:175], v[92:107]
    ds_read_b64_tr_b16 v[160:161], v54 offset:26624
    ds_read_b64_tr_b16 v[162:163], v54 offset:27648
    s_add_u32 m0, s82, 0x4000
    s_add_u32 s98, s27, s41
    buffer_load_dwordx4 v30, s[88:91], s98 offen lds
    buffer_load_ushort v125, v237, s[52:55], s99 offen offset:896
    v_mfma_f32_32x32x16_bf16 v[92:107], a[116:119], v[176:179], v[92:107]
    ds_read_b64_tr_b16 v[164:165], v56 offset:24576
    ds_read_b64_tr_b16 v[166:167], v56 offset:25600
    buffer_load_dwordx4 v31, s[88:91], s98 offen offset:1024 lds
    buffer_load_ushort v126, v237, s[52:55], s99 offen offset:1792
    s_waitcnt lgkmcnt(6)
    v_mfma_f32_32x32x16_bf16 v[92:107], a[120:123], v[180:183], v[92:107]
    ds_read_b64_tr_b16 v[168:169], v56 offset:26624
    ds_read_b64_tr_b16 v[170:171], v56 offset:27648
    buffer_load_dwordx4 v32, s[88:91], s98 offen offset:2048 lds
    buffer_load_ushort v127, v237, s[52:55], s99 offen offset:2688
    v_mfma_f32_32x32x16_bf16 v[92:107], a[124:127], v[184:187], v[92:107]
    ds_read_b64_tr_b16 v[172:173], v55 offset:24576
    ds_read_b64_tr_b16 v[174:175], v55 offset:25600
    buffer_load_dwordx4 v33, s[88:91], s98 offen offset:3072 lds
    s_movk_i32 s99, 0xe00
    s_waitcnt lgkmcnt(6)
    v_mfma_f32_32x32x16_bf16 v[92:107], v[204:207], v[156:159], v[92:107]
    ds_read_b64_tr_b16 v[176:177], v55 offset:26624
    ds_read_b64_tr_b16 v[178:179], v55 offset:27648
    s_add_u32 m0, s82, 0x5000
    s_mul_i32 s98, s27, 0x1c0
    buffer_load_dwordx4 v22, s[68:71], s98 offen lds
    buffer_load_ushort v128, v237, s[52:55], s99 offen
    buffer_load_ushort v129, v237, s[52:55], s99 offen offset:896
    v_mfma_f32_32x32x16_bf16 v[92:107], v[208:211], v[160:163], v[92:107]
    ds_read_b64_tr_b16 v[180:181], v57 offset:24576
    ds_read_b64_tr_b16 v[182:183], v57 offset:25600
    buffer_load_dwordx4 v23, s[68:71], s98 offen offset:1024 lds
    buffer_load_ushort v130, v237, s[52:55], s99 offen offset:1792
    s_waitcnt lgkmcnt(6)
    v_mfma_f32_32x32x16_bf16 v[92:107], v[212:215], v[164:167], v[92:107]
    ds_read_b64_tr_b16 v[184:185], v57 offset:26624
    ds_read_b64_tr_b16 v[186:187], v57 offset:27648
    buffer_load_dwordx4 v24, s[68:71], s98 offen offset:2048 lds
    buffer_load_ushort v131, v237, s[52:55], s99 offen offset:2688
    s_barrier
    v_mfma_f32_32x32x16_bf16 v[92:107], v[216:219], v[168:171], v[92:107]
    ds_read_b128 v[156:159], v42 offset:8192
    buffer_load_dwordx4 v25, s[68:71], s98 offen offset:3072 lds
    s_movk_i32 s99, 0x1c00
    s_waitcnt lgkmcnt(5)
    v_mfma_f32_32x32x16_bf16 v[92:107], a[128:131], v[172:175], v[92:107]
    ds_read_b128 v[160:163], v43 offset:8192
    s_add_u32 m0, s82, 0
    s_add_u32 s98, s28, s40
    buffer_load_dwordx4 v30, s[88:91], s98 offen lds
    buffer_load_ushort v132, v237, s[52:55], s99 offen
    v_mfma_f32_32x32x16_bf16 v[92:107], a[132:135], v[176:179], v[92:107]
    ds_read_b128 v[164:167], v46 offset:8192
    buffer_load_dwordx4 v31, s[88:91], s98 offen offset:1024 lds
    buffer_load_ushort v133, v237, s[52:55], s99 offen offset:896
    s_waitcnt lgkmcnt(3)
    v_mfma_f32_32x32x16_bf16 v[92:107], a[136:139], v[180:183], v[92:107]
    ds_read_b128 v[168:171], v47 offset:8192
    buffer_load_dwordx4 v32, s[88:91], s98 offen offset:2048 lds
    buffer_load_ushort v134, v237, s[52:55], s99 offen offset:1792
    buffer_load_ushort v135, v237, s[52:55], s99 offen offset:2688
    v_mfma_f32_32x32x16_bf16 v[92:107], a[140:143], v[184:187], v[92:107]
    ds_read_b128 v[172:175], v44 offset:8192
    buffer_load_dwordx4 v33, s[88:91], s98 offen offset:3072 lds
    s_movk_i32 s99, 0x2a00
    s_waitcnt lgkmcnt(3)
    v_mfma_f32_32x32x16_bf16 v[92:107], a[144:147], v[156:159], v[92:107]
    ds_read_b128 v[176:179], v45 offset:8192
    buffer_load_ushort v136, v237, s[52:55], s99 offen
    v_mfma_f32_32x32x16_bf16 v[92:107], a[148:151], v[160:163], v[92:107]
    ds_read_b128 v[180:183], v48 offset:8192
    s_add_u32 m0, s82, 0x8000
    s_add_u32 s98, s28, s41
    buffer_load_dwordx4 v30, s[88:91], s98 offen lds
    buffer_load_ushort v137, v237, s[52:55], s99 offen offset:896
    s_waitcnt lgkmcnt(3)
    v_mfma_f32_32x32x16_bf16 v[92:107], a[152:155], v[164:167], v[92:107]
    ds_read_b128 v[184:187], v49 offset:8192
    buffer_load_ushort v138, v237, s[52:55], s99 offen offset:1792
    s_waitcnt vmcnt(28)
    s_barrier
    v_mfma_f32_32x32x16_bf16 v[92:107], a[156:159], v[168:171], v[92:107]
    ds_read_b64_tr_b16 v[156:157], v54 offset:12288
    ds_read_b64_tr_b16 v[158:159], v54 offset:13312
    buffer_load_dwordx4 v31, s[88:91], s98 offen offset:1024 lds
    buffer_load_ushort v139, v237, s[52:55], s99 offen offset:2688
    s_waitcnt lgkmcnt(4)
    v_mfma_f32_32x32x16_bf16 v[92:107], a[160:163], v[172:175], v[92:107]
    ds_read_b64_tr_b16 v[160:161], v54 offset:14336
    ds_read_b64_tr_b16 v[162:163], v54 offset:15360
    buffer_load_dwordx4 v32, s[88:91], s98 offen offset:2048 lds
    v_mfma_f32_32x32x16_bf16 v[92:107], a[164:167], v[176:179], v[92:107]
    ds_read_b64_tr_b16 v[164:165], v56 offset:12288
    ds_read_b64_tr_b16 v[166:167], v56 offset:13312
    buffer_load_dwordx4 v33, s[88:91], s98 offen offset:3072 lds
    s_waitcnt lgkmcnt(6)
    v_mfma_f32_32x32x16_bf16 v[92:107], a[168:171], v[180:183], v[92:107]
    ds_read_b64_tr_b16 v[168:169], v56 offset:14336
    ds_read_b64_tr_b16 v[170:171], v56 offset:15360
    v_mfma_f32_32x32x16_bf16 v[92:107], a[172:175], v[184:187], v[92:107]
    ds_read_b64_tr_b16 v[172:173], v55 offset:12288
    ds_read_b64_tr_b16 v[174:175], v55 offset:13312
    s_add_u32 m0, s82, 0x9000
    s_mul_i32 s98, s28, 0x1c0
    buffer_load_dwordx4 v22, s[68:71], s98 offen lds
    s_waitcnt lgkmcnt(6)
    v_mfma_f32_32x32x16_bf16 v[108:123], v[188:191], v[156:159], 0
    ds_read_b64_tr_b16 v[176:177], v55 offset:14336
    ds_read_b64_tr_b16 v[178:179], v55 offset:15360
    v_mfma_f32_32x32x16_bf16 v[108:123], v[192:195], v[160:163], v[108:123]
    ds_read_b64_tr_b16 v[180:181], v57 offset:12288
    ds_read_b64_tr_b16 v[182:183], v57 offset:13312
    buffer_load_dwordx4 v23, s[68:71], s98 offen offset:1024 lds
    s_waitcnt lgkmcnt(6)
    v_mfma_f32_32x32x16_bf16 v[108:123], v[196:199], v[164:167], v[108:123]
    ds_read_b64_tr_b16 v[184:185], v57 offset:14336
    ds_read_b64_tr_b16 v[186:187], v57 offset:15360
    v_add_u32 v92, 0x10000, v92
    v_and_or_b32 v92, v92, s92, v247
    v_cvt_pk_bf16_f32 v12, v92, v93
    v_add_u32 v94, 0x10000, v94
    s_waitcnt vmcnt(26)
    s_barrier
    v_mfma_f32_32x32x16_bf16 v[108:123], v[200:203], v[168:171], v[108:123]
    ds_read_b64_tr_b16 v[156:157], v54 offset:16384
    ds_read_b64_tr_b16 v[158:159], v54 offset:17408
    buffer_load_dwordx4 v24, s[68:71], s98 offen offset:2048 lds
    v_and_or_b32 v94, v94, s92, v248
    v_cvt_pk_bf16_f32 v13, v94, v95
    v_add_u32 v96, 0x10000, v96
    v_and_or_b32 v96, v96, s92, v249
    s_waitcnt lgkmcnt(6)
    v_mfma_f32_32x32x16_bf16 v[108:123], a[112:115], v[172:175], v[108:123]
    ds_read_b64_tr_b16 v[160:161], v54 offset:18432
    ds_read_b64_tr_b16 v[162:163], v54 offset:19456
    buffer_load_dwordx4 v25, s[68:71], s98 offen offset:3072 lds
    v_cvt_pk_bf16_f32 v14, v96, v97
    v_add_u32 v98, 0x10000, v98
    v_and_or_b32 v98, v98, s92, v250
    v_cvt_pk_bf16_f32 v15, v98, v99
    v_mfma_f32_32x32x16_bf16 v[108:123], a[116:119], v[176:179], v[108:123]
    ds_read_b64_tr_b16 v[164:165], v56 offset:16384
    ds_read_b64_tr_b16 v[166:167], v56 offset:17408
    s_add_u32 m0, s82, 0x7000
    s_add_u32 s98, s29, s40
    buffer_load_dwordx4 v30, s[88:91], s98 offen lds
    v_add_u32 v100, 0x10000, v100
    v_and_or_b32 v100, v100, s92, v247
    v_cvt_pk_bf16_f32 v16, v100, v101
    v_add_u32 v102, 0x10000, v102
    s_waitcnt lgkmcnt(6)
    v_mfma_f32_32x32x16_bf16 v[108:123], a[120:123], v[180:183], v[108:123]
    ds_read_b64_tr_b16 v[168:169], v56 offset:18432
    ds_read_b64_tr_b16 v[170:171], v56 offset:19456
    v_and_or_b32 v102, v102, s92, v248
    v_cvt_pk_bf16_f32 v17, v102, v103
    v_add_u32 v104, 0x10000, v104
    v_and_or_b32 v104, v104, s92, v249
    v_mfma_f32_32x32x16_bf16 v[108:123], a[124:127], v[184:187], v[108:123]
    ds_read_b64_tr_b16 v[172:173], v55 offset:16384
    ds_read_b64_tr_b16 v[174:175], v55 offset:17408
    buffer_load_dwordx4 v31, s[88:91], s98 offen offset:1024 lds
    v_cvt_pk_bf16_f32 v18, v104, v105
    v_add_u32 v106, 0x10000, v106
    v_and_or_b32 v106, v106, s92, v250
    v_cvt_pk_bf16_f32 v19, v106, v107
    s_waitcnt lgkmcnt(6)
    v_mfma_f32_32x32x16_bf16 v[108:123], v[204:207], v[156:159], v[108:123]
    ds_read_b64_tr_b16 v[176:177], v55 offset:18432
    ds_read_b64_tr_b16 v[178:179], v55 offset:19456
    s_lshl_b32 s99, s26, 9
    buffer_store_dwordx4 v[12:15], v239, s[64:67], s99 offen sc1
    buffer_store_dwordx4 v[16:19], v239, s[64:67], s99 offen offset:1024 sc1
    v_mfma_f32_32x32x16_bf16 v[108:123], v[208:211], v[160:163], v[108:123]
    ds_read_b64_tr_b16 v[180:181], v57 offset:16384
    ds_read_b64_tr_b16 v[182:183], v57 offset:17408
    buffer_load_dwordx4 v32, s[88:91], s98 offen offset:2048 lds
    s_waitcnt lgkmcnt(6)
    v_mfma_f32_32x32x16_bf16 v[108:123], v[212:215], v[164:167], v[108:123]
    ds_read_b64_tr_b16 v[184:185], v57 offset:18432
    ds_read_b64_tr_b16 v[186:187], v57 offset:19456
    s_waitcnt vmcnt(25)
    s_barrier
    v_mfma_f32_32x32x16_bf16 v[108:123], v[216:219], v[168:171], v[108:123]
    ds_read_b128 v[156:159], v42 offset:20480
    buffer_load_dwordx4 v33, s[88:91], s98 offen offset:3072 lds
    s_waitcnt lgkmcnt(5)
    v_mfma_f32_32x32x16_bf16 v[108:123], a[128:131], v[172:175], v[108:123]
    ds_read_b128 v[160:163], v43 offset:20480
    v_lshlrev_b32 v238, 16, v238
    v_lshlrev_b32 v124, 16, v124
    v_mfma_f32_32x32x16_bf16 v[108:123], a[132:135], v[176:179], v[108:123]
    ds_read_b128 v[164:167], v46 offset:20480
    s_add_u32 m0, s82, 0x1000
    s_add_u32 s98, s29, s41
    buffer_load_dwordx4 v30, s[88:91], s98 offen lds
    v_lshlrev_b32 v125, 16, v125
    v_lshlrev_b32 v126, 16, v126
    s_waitcnt lgkmcnt(3)
    v_mfma_f32_32x32x16_bf16 v[108:123], a[136:139], v[180:183], v[108:123]
    ds_read_b128 v[168:171], v47 offset:20480
    v_lshlrev_b32 v127, 16, v127
    v_lshlrev_b32 v128, 16, v128
    v_mfma_f32_32x32x16_bf16 v[108:123], a[140:143], v[184:187], v[108:123]
    ds_read_b128 v[172:175], v44 offset:20480
    buffer_load_dwordx4 v31, s[88:91], s98 offen offset:1024 lds
    v_lshlrev_b32 v129, 16, v129
    v_lshlrev_b32 v130, 16, v130
    s_waitcnt lgkmcnt(3)
    v_mfma_f32_32x32x16_bf16 v[108:123], a[144:147], v[156:159], v[108:123]
    ds_read_b128 v[176:179], v45 offset:20480
    v_lshlrev_b32 v131, 16, v131
    s_waitcnt vmcnt(26)
    v_lshlrev_b32 v132, 16, v132
    v_mfma_f32_32x32x16_bf16 v[108:123], a[148:151], v[160:163], v[108:123]
    ds_read_b128 v[180:183], v48 offset:20480
    buffer_load_dwordx4 v32, s[88:91], s98 offen offset:2048 lds
    s_waitcnt vmcnt(25)
    v_lshlrev_b32 v133, 16, v133
    s_waitcnt vmcnt(23)
    v_lshlrev_b32 v134, 16, v134
    s_waitcnt lgkmcnt(3)
    v_mfma_f32_32x32x16_bf16 v[108:123], a[152:155], v[164:167], v[108:123]
    ds_read_b128 v[184:187], v49 offset:20480
    s_waitcnt vmcnt(22)
    v_lshlrev_b32 v135, 16, v135
    s_waitcnt vmcnt(20)
    v_lshlrev_b32 v136, 16, v136
    s_barrier
    v_mfma_f32_32x32x16_bf16 v[108:123], a[156:159], v[168:171], v[108:123]
    ds_read_b64_tr_b16 v[156:157], v54
    ds_read_b64_tr_b16 v[158:159], v54 offset:1024
    buffer_load_dwordx4 v33, s[88:91], s98 offen offset:3072 lds
    s_waitcnt vmcnt(19)
    v_lshlrev_b32 v137, 16, v137
    s_waitcnt vmcnt(18)
    v_lshlrev_b32 v138, 16, v138
    s_waitcnt lgkmcnt(4)
    v_mfma_f32_32x32x16_bf16 v[108:123], a[160:163], v[172:175], v[108:123]
    ds_read_b64_tr_b16 v[160:161], v54 offset:2048
    ds_read_b64_tr_b16 v[162:163], v54 offset:3072
    s_waitcnt vmcnt(16)
    v_lshlrev_b32 v139, 16, v139
    v_mul_f32 v124, v124, v238
    v_mfma_f32_32x32x16_bf16 v[108:123], a[164:167], v[176:179], v[108:123]
    ds_read_b64_tr_b16 v[164:165], v56
    ds_read_b64_tr_b16 v[166:167], v56 offset:1024
    s_add_u32 m0, s82, 0x6000
    s_mul_i32 s98, s29, 0x1c0
    buffer_load_dwordx4 v22, s[68:71], s98 offen lds
    v_mul_f32 v125, v125, v238
    v_mul_f32 v126, v126, v238
    s_waitcnt lgkmcnt(6)
    v_mfma_f32_32x32x16_bf16 v[108:123], a[168:171], v[180:183], v[108:123]
    ds_read_b64_tr_b16 v[168:169], v56 offset:2048
    ds_read_b64_tr_b16 v[170:171], v56 offset:3072
    v_mul_f32 v127, v127, v238
    v_mul_f32 v128, v128, v238
    v_mfma_f32_32x32x16_bf16 v[108:123], a[172:175], v[184:187], v[108:123]
    ds_read_b64_tr_b16 v[172:173], v55
    ds_read_b64_tr_b16 v[174:175], v55 offset:1024
    buffer_load_dwordx4 v23, s[68:71], s98 offen offset:1024 lds
    v_mul_f32 v129, v129, v238
    s_waitcnt lgkmcnt(6)
    v_mfma_f32_32x32x16_bf16 v[92:107], v[188:191], v[156:159], 0
    ds_read_b64_tr_b16 v[176:177], v55 offset:2048
    ds_read_b64_tr_b16 v[178:179], v55 offset:3072
    v_mul_f32 v130, v130, v238
    v_mul_f32 v131, v131, v238
    v_mfma_f32_32x32x16_bf16 v[92:107], v[192:195], v[160:163], v[92:107]
    ds_read_b64_tr_b16 v[180:181], v57
    ds_read_b64_tr_b16 v[182:183], v57 offset:1024
    buffer_load_dwordx4 v24, s[68:71], s98 offen offset:2048 lds
    v_mul_f32 v132, v132, v238
    v_mul_f32 v133, v133, v238
    s_waitcnt lgkmcnt(6)
    v_mfma_f32_32x32x16_bf16 v[92:107], v[196:199], v[164:167], v[92:107]
    ds_read_b64_tr_b16 v[184:185], v57 offset:2048
    ds_read_b64_tr_b16 v[186:187], v57 offset:3072
    v_add_u32 v108, 0x10000, v108
    v_and_or_b32 v108, v108, s92, v247
    v_cvt_pk_bf16_f32 v12, v108, v109
    v_add_u32 v110, 0x10000, v110
    v_mul_f32 v134, v134, v238
    v_mul_f32 v135, v135, v238
    s_waitcnt vmcnt(17)
    s_barrier
    v_mfma_f32_32x32x16_bf16 v[92:107], v[200:203], v[168:171], v[92:107]
    ds_read_b64_tr_b16 v[156:157], v54 offset:32768
    ds_read_b64_tr_b16 v[158:159], v54 offset:33792
    buffer_load_dwordx4 v25, s[68:71], s98 offen offset:3072 lds
    v_and_or_b32 v110, v110, s92, v248
    v_cvt_pk_bf16_f32 v13, v110, v111
    v_add_u32 v112, 0x10000, v112
    v_and_or_b32 v112, v112, s92, v249
    v_mul_f32 v136, v136, v238
    v_mul_f32 v137, v137, v238
    s_waitcnt lgkmcnt(6)
    v_mfma_f32_32x32x16_bf16 v[92:107], a[112:115], v[172:175], v[92:107]
    ds_read_b64_tr_b16 v[160:161], v54 offset:34816
    ds_read_b64_tr_b16 v[162:163], v54 offset:35840
    v_cvt_pk_bf16_f32 v14, v112, v113
    v_add_u32 v114, 0x10000, v114
    v_and_or_b32 v114, v114, s92, v250
    v_cvt_pk_bf16_f32 v15, v114, v115
    v_mul_f32 v138, v138, v238
    v_mul_f32 v139, v139, v238
    v_mfma_f32_32x32x16_bf16 v[92:107], a[116:119], v[176:179], v[92:107]
    ds_read_b64_tr_b16 v[164:165], v56 offset:32768
    ds_read_b64_tr_b16 v[166:167], v56 offset:33792
    s_add_u32 m0, s82, 0x2000
    s_add_u32 s98, s37, s40
    buffer_load_dwordx4 v30, s[88:91], s98 offen lds
    v_add_u32 v116, 0x10000, v116
    v_and_or_b32 v116, v116, s92, v247
    v_cvt_pk_bf16_f32 v16, v116, v117
    v_add_u32 v118, 0x10000, v118
    v_cvt_pk_bf16_f32 v124, 0, v124
    v_cvt_pk_bf16_f32 v125, 0, v125
    s_waitcnt lgkmcnt(6)
    v_mfma_f32_32x32x16_bf16 v[92:107], a[120:123], v[180:183], v[92:107]
    ds_read_b64_tr_b16 v[168:169], v56 offset:34816
    ds_read_b64_tr_b16 v[170:171], v56 offset:35840
    v_and_or_b32 v118, v118, s92, v248
    v_cvt_pk_bf16_f32 v17, v118, v119
    v_add_u32 v120, 0x10000, v120
    v_and_or_b32 v120, v120, s92, v249
    v_cvt_pk_bf16_f32 v126, 0, v126
    v_cvt_pk_bf16_f32 v127, 0, v127
    v_mfma_f32_32x32x16_bf16 v[92:107], a[124:127], v[184:187], v[92:107]
    ds_read_b64_tr_b16 v[172:173], v55 offset:32768
    ds_read_b64_tr_b16 v[174:175], v55 offset:33792
    buffer_load_dwordx4 v31, s[88:91], s98 offen offset:1024 lds
    v_cvt_pk_bf16_f32 v18, v120, v121
    v_add_u32 v122, 0x10000, v122
    v_and_or_b32 v122, v122, s92, v250
    v_cvt_pk_bf16_f32 v19, v122, v123
    v_cvt_pk_bf16_f32 v128, 0, v128
    v_cvt_pk_bf16_f32 v129, 0, v129
    s_waitcnt lgkmcnt(6)
    v_mfma_f32_32x32x16_bf16 v[92:107], v[204:207], v[156:159], v[92:107]
    ds_read_b64_tr_b16 v[176:177], v55 offset:34816
    ds_read_b64_tr_b16 v[178:179], v55 offset:35840
    s_lshl_b32 s99, s27, 9
    buffer_store_dwordx4 v[12:15], v239, s[64:67], s99 offen sc1
    buffer_store_dwordx4 v[16:19], v239, s[64:67], s99 offen offset:1024 sc1
    v_cvt_pk_bf16_f32 v130, 0, v130
    v_cvt_pk_bf16_f32 v131, 0, v131
    v_mfma_f32_32x32x16_bf16 v[92:107], v[208:211], v[160:163], v[92:107]
    ds_read_b64_tr_b16 v[180:181], v57 offset:32768
    ds_read_b64_tr_b16 v[182:183], v57 offset:33792
    buffer_load_dwordx4 v32, s[88:91], s98 offen offset:2048 lds
    v_cvt_pk_bf16_f32 v132, 0, v132
    v_cvt_pk_bf16_f32 v133, 0, v133
    s_waitcnt lgkmcnt(6)
    v_mfma_f32_32x32x16_bf16 v[92:107], v[212:215], v[164:167], v[92:107]
    ds_read_b64_tr_b16 v[184:185], v57 offset:34816
    ds_read_b64_tr_b16 v[186:187], v57 offset:35840
    v_cvt_pk_bf16_f32 v134, 0, v134
    s_waitcnt vmcnt(19)
    s_barrier
    v_mfma_f32_32x32x16_bf16 v[92:107], v[216:219], v[168:171], v[92:107]
    ds_read_b128 v[156:159], v42 offset:36864
    buffer_load_dwordx4 v33, s[88:91], s98 offen offset:3072 lds
    v_cvt_pk_bf16_f32 v135, 0, v135
    v_cvt_pk_bf16_f32 v136, 0, v136
    s_waitcnt lgkmcnt(5)
    v_mfma_f32_32x32x16_bf16 v[92:107], a[128:131], v[172:175], v[92:107]
    ds_read_b128 v[160:163], v43 offset:36864
    v_cvt_pk_bf16_f32 v137, 0, v137
    v_cvt_pk_bf16_f32 v138, 0, v138
    v_mfma_f32_32x32x16_bf16 v[92:107], a[132:135], v[176:179], v[92:107]
    ds_read_b128 v[164:167], v46 offset:36864
    s_add_u32 m0, s82, 0x3000
    s_add_u32 s98, s37, s41
    buffer_load_dwordx4 v30, s[88:91], s98 offen lds
    v_cvt_pk_bf16_f32 v139, 0, v139
    v_mul_f32_dpp v124, v230, v124 row_newbcast:0 row_mask:0xf bank_mask:0xf
    s_waitcnt lgkmcnt(3)
    v_mfma_f32_32x32x16_bf16 v[92:107], a[136:139], v[180:183], v[92:107]
    ds_read_b128 v[168:171], v47 offset:36864
    v_mul_f32_dpp v125, v230, v125 row_newbcast:1 row_mask:0xf bank_mask:0xf
    v_mul_f32_dpp v126, v230, v126 row_newbcast:2 row_mask:0xf bank_mask:0xf
    v_mfma_f32_32x32x16_bf16 v[92:107], a[140:143], v[184:187], v[92:107]
    ds_read_b128 v[172:175], v44 offset:36864
    buffer_load_dwordx4 v31, s[88:91], s98 offen offset:1024 lds
    v_mul_f32_dpp v127, v230, v127 row_newbcast:3 row_mask:0xf bank_mask:0xf
    v_mul_f32_dpp v128, v230, v128 row_newbcast:4 row_mask:0xf bank_mask:0xf
    s_waitcnt lgkmcnt(3)
    v_mfma_f32_32x32x16_bf16 v[92:107], a[144:147], v[156:159], v[92:107]
    ds_read_b128 v[176:179], v45 offset:36864
    v_mul_f32_dpp v129, v230, v129 row_newbcast:5 row_mask:0xf bank_mask:0xf
    v_mul_f32_dpp v130, v230, v130 row_newbcast:6 row_mask:0xf bank_mask:0xf
    v_mfma_f32_32x32x16_bf16 v[92:107], a[148:151], v[160:163], v[92:107]
    ds_read_b128 v[180:183], v48 offset:36864
    buffer_load_dwordx4 v32, s[88:91], s98 offen offset:2048 lds
    v_mul_f32_dpp v131, v230, v131 row_newbcast:7 row_mask:0xf bank_mask:0xf
    v_mul_f32_dpp v132, v230, v132 row_newbcast:8 row_mask:0xf bank_mask:0xf
    s_waitcnt lgkmcnt(3)
    v_mfma_f32_32x32x16_bf16 v[92:107], a[152:155], v[164:167], v[92:107]
    ds_read_b128 v[184:187], v49 offset:36864
    v_mul_f32_dpp v133, v230, v133 row_newbcast:9 row_mask:0xf bank_mask:0xf
    v_mul_f32_dpp v134, v230, v134 row_newbcast:10 row_mask:0xf bank_mask:0xf
    s_waitcnt vmcnt(17)
    s_barrier
    v_mfma_f32_32x32x16_bf16 v[92:107], a[156:159], v[168:171], v[92:107]
    ds_read_b64_tr_b16 v[156:157], v54 offset:28672
    ds_read_b64_tr_b16 v[158:159], v54 offset:29696
    buffer_load_dwordx4 v33, s[88:91], s98 offen offset:3072 lds
    v_mul_f32_dpp v135, v230, v135 row_newbcast:11 row_mask:0xf bank_mask:0xf
    v_mul_f32_dpp v136, v230, v136 row_newbcast:12 row_mask:0xf bank_mask:0xf
    s_waitcnt lgkmcnt(4)
    v_mfma_f32_32x32x16_bf16 v[92:107], a[160:163], v[172:175], v[92:107]
    ds_read_b64_tr_b16 v[160:161], v54 offset:30720
    ds_read_b64_tr_b16 v[162:163], v54 offset:31744
    v_mul_f32_dpp v137, v230, v137 row_newbcast:13 row_mask:0xf bank_mask:0xf
    v_mul_f32_dpp v138, v230, v138 row_newbcast:14 row_mask:0xf bank_mask:0xf
    v_mfma_f32_32x32x16_bf16 v[92:107], a[164:167], v[176:179], v[92:107]
    ds_read_b64_tr_b16 v[164:165], v56 offset:28672
    ds_read_b64_tr_b16 v[166:167], v56 offset:29696
    s_add_u32 m0, s82, 0x4000
    s_mul_i32 s98, s37, 0x1c0
    buffer_load_dwordx4 v22, s[68:71], s98 offen lds
    v_mul_f32_dpp v139, v230, v139 row_newbcast:15 row_mask:0xf bank_mask:0xf
    s_waitcnt lgkmcnt(6)
    v_mfma_f32_32x32x16_bf16 v[92:107], a[168:171], v[180:183], v[92:107]
    ds_read_b64_tr_b16 v[168:169], v56 offset:30720
    ds_read_b64_tr_b16 v[170:171], v56 offset:31744
    v_mfma_f32_32x32x16_bf16 v[92:107], a[172:175], v[184:187], v[92:107]
    ds_read_b64_tr_b16 v[172:173], v55 offset:28672
    ds_read_b64_tr_b16 v[174:175], v55 offset:29696
    buffer_load_dwordx4 v23, s[68:71], s98 offen offset:1024 lds
    s_waitcnt lgkmcnt(6)
    v_mfma_f32_32x32x16_bf16 v[108:123], v[188:191], v[156:159], 0
    ds_read_b64_tr_b16 v[176:177], v55 offset:30720
    ds_read_b64_tr_b16 v[178:179], v55 offset:31744
    v_mfma_f32_32x32x16_bf16 v[108:123], v[192:195], v[160:163], v[108:123]
    ds_read_b64_tr_b16 v[180:181], v57 offset:28672
    ds_read_b64_tr_b16 v[182:183], v57 offset:29696
    buffer_load_dwordx4 v24, s[68:71], s98 offen offset:2048 lds
    s_waitcnt lgkmcnt(6)
    v_mfma_f32_32x32x16_bf16 v[108:123], v[196:199], v[164:167], v[108:123]
    ds_read_b64_tr_b16 v[184:185], v57 offset:30720
    ds_read_b64_tr_b16 v[186:187], v57 offset:31744
    v_add_u32 v92, 0x10000, v92
    v_and_or_b32 v92, v92, s92, v247
    v_cvt_pk_bf16_f32 v12, v92, v93
    v_add_u32 v94, 0x10000, v94
    s_waitcnt vmcnt(17)
    s_barrier
    v_mfma_f32_32x32x16_bf16 v[108:123], v[200:203], v[168:171], v[108:123]
    ds_read_b64_tr_b16 v[156:157], v54 offset:4096
    ds_read_b64_tr_b16 v[158:159], v54 offset:5120
    buffer_load_dwordx4 v25, s[68:71], s98 offen offset:3072 lds
    v_and_or_b32 v94, v94, s92, v248
    v_cvt_pk_bf16_f32 v13, v94, v95
    v_add_u32 v96, 0x10000, v96
    v_and_or_b32 v96, v96, s92, v249
    s_waitcnt lgkmcnt(6)
    v_mfma_f32_32x32x16_bf16 v[108:123], a[112:115], v[172:175], v[108:123]
    ds_read_b64_tr_b16 v[160:161], v54 offset:6144
    ds_read_b64_tr_b16 v[162:163], v54 offset:7168
    v_cvt_pk_bf16_f32 v14, v96, v97
    v_add_u32 v98, 0x10000, v98
    v_and_or_b32 v98, v98, s92, v250
    v_cvt_pk_bf16_f32 v15, v98, v99
    v_mfma_f32_32x32x16_bf16 v[108:123], a[116:119], v[176:179], v[108:123]
    ds_read_b64_tr_b16 v[164:165], v56 offset:4096
    ds_read_b64_tr_b16 v[166:167], v56 offset:5120
    s_add_u32 m0, s82, 0x5000
    s_add_u32 s98, s38, s40
    buffer_load_dwordx4 v30, s[88:91], s98 offen lds
    v_add_u32 v100, 0x10000, v100
    v_and_or_b32 v100, v100, s92, v247
    v_cvt_pk_bf16_f32 v16, v100, v101
    v_add_u32 v102, 0x10000, v102
    s_waitcnt lgkmcnt(6)
    v_mfma_f32_32x32x16_bf16 v[108:123], a[120:123], v[180:183], v[108:123]
    ds_read_b64_tr_b16 v[168:169], v56 offset:6144
    ds_read_b64_tr_b16 v[170:171], v56 offset:7168
    v_and_or_b32 v102, v102, s92, v248
    v_cvt_pk_bf16_f32 v17, v102, v103
    v_add_u32 v104, 0x10000, v104
    v_and_or_b32 v104, v104, s92, v249
    v_mfma_f32_32x32x16_bf16 v[108:123], a[124:127], v[184:187], v[108:123]
    ds_read_b64_tr_b16 v[172:173], v55 offset:4096
    ds_read_b64_tr_b16 v[174:175], v55 offset:5120
    buffer_load_dwordx4 v31, s[88:91], s98 offen offset:1024 lds
    v_cvt_pk_bf16_f32 v18, v104, v105
    v_add_u32 v106, 0x10000, v106
    v_and_or_b32 v106, v106, s92, v250
    v_cvt_pk_bf16_f32 v19, v106, v107
    s_waitcnt lgkmcnt(6)
    v_mfma_f32_32x32x16_bf16 v[108:123], v[204:207], v[156:159], v[108:123]
    ds_read_b64_tr_b16 v[176:177], v55 offset:6144
    ds_read_b64_tr_b16 v[178:179], v55 offset:7168
    s_lshl_b32 s99, s28, 9
    buffer_store_dwordx4 v[12:15], v239, s[64:67], s99 offen sc1
    buffer_store_dwordx4 v[16:19], v239, s[64:67], s99 offen offset:1024 sc1
    v_mfma_f32_32x32x16_bf16 v[108:123], v[208:211], v[160:163], v[108:123]
    ds_read_b64_tr_b16 v[180:181], v57 offset:4096
    ds_read_b64_tr_b16 v[182:183], v57 offset:5120
    buffer_load_dwordx4 v32, s[88:91], s98 offen offset:2048 lds
    s_waitcnt lgkmcnt(6)
    v_mfma_f32_32x32x16_bf16 v[108:123], v[212:215], v[164:167], v[108:123]
    ds_read_b64_tr_b16 v[184:185], v57 offset:6144
    ds_read_b64_tr_b16 v[186:187], v57 offset:7168
    s_waitcnt vmcnt(19)
    s_barrier
    v_mfma_f32_32x32x16_bf16 v[108:123], v[216:219], v[168:171], v[108:123]
    ds_read_b128 v[156:159], v42 offset:24576
    buffer_load_dwordx4 v33, s[88:91], s98 offen offset:3072 lds
    s_waitcnt lgkmcnt(5)
    v_mfma_f32_32x32x16_bf16 v[108:123], a[128:131], v[172:175], v[108:123]
    ds_read_b128 v[160:163], v43 offset:24576
    v_mfma_f32_32x32x16_bf16 v[108:123], a[132:135], v[176:179], v[108:123]
    ds_read_b128 v[164:167], v46 offset:24576
    s_add_u32 m0, s82, 0
    s_add_u32 s98, s38, s41
    buffer_load_dwordx4 v30, s[88:91], s98 offen lds
    s_waitcnt lgkmcnt(3)
    v_mfma_f32_32x32x16_bf16 v[108:123], a[136:139], v[180:183], v[108:123]
    ds_read_b128 v[168:171], v47 offset:24576
    v_mfma_f32_32x32x16_bf16 v[108:123], a[140:143], v[184:187], v[108:123]
    ds_read_b128 v[172:175], v44 offset:24576
    buffer_load_dwordx4 v31, s[88:91], s98 offen offset:1024 lds
    s_waitcnt lgkmcnt(3)
    v_mfma_f32_32x32x16_bf16 v[108:123], a[144:147], v[156:159], v[108:123]
    ds_read_b128 v[176:179], v45 offset:24576
    v_mfma_f32_32x32x16_bf16 v[108:123], a[148:151], v[160:163], v[108:123]
    ds_read_b128 v[180:183], v48 offset:24576
    buffer_load_dwordx4 v32, s[88:91], s98 offen offset:2048 lds
    s_waitcnt lgkmcnt(3)
    v_mfma_f32_32x32x16_bf16 v[108:123], a[152:155], v[164:167], v[108:123]
    ds_read_b128 v[184:187], v49 offset:24576
    s_waitcnt vmcnt(17)
    s_barrier
    v_mfma_f32_32x32x16_bf16 v[108:123], a[156:159], v[168:171], v[108:123]
    ds_read_b64_tr_b16 v[156:157], v54 offset:8192
    ds_read_b64_tr_b16 v[158:159], v54 offset:9216
    buffer_load_dwordx4 v33, s[88:91], s98 offen offset:3072 lds
    s_waitcnt lgkmcnt(4)
    v_mfma_f32_32x32x16_bf16 v[108:123], a[160:163], v[172:175], v[108:123]
    ds_read_b64_tr_b16 v[160:161], v54 offset:10240
    ds_read_b64_tr_b16 v[162:163], v54 offset:11264
    v_mfma_f32_32x32x16_bf16 v[108:123], a[164:167], v[176:179], v[108:123]
    ds_read_b64_tr_b16 v[164:165], v56 offset:8192
    ds_read_b64_tr_b16 v[166:167], v56 offset:9216
    s_add_u32 m0, s82, 0x8000
    s_mul_i32 s98, s38, 0x1c0
    buffer_load_dwordx4 v22, s[68:71], s98 offen lds
    s_waitcnt lgkmcnt(6)
    v_mfma_f32_32x32x16_bf16 v[108:123], a[168:171], v[180:183], v[108:123]
    ds_read_b64_tr_b16 v[168:169], v56 offset:10240
    ds_read_b64_tr_b16 v[170:171], v56 offset:11264
    v_mfma_f32_32x32x16_bf16 v[108:123], a[172:175], v[184:187], v[108:123]
    ds_read_b64_tr_b16 v[172:173], v55 offset:8192
    ds_read_b64_tr_b16 v[174:175], v55 offset:9216
    buffer_load_dwordx4 v23, s[68:71], s98 offen offset:1024 lds
    s_waitcnt lgkmcnt(6)
    v_mfma_f32_32x32x16_bf16 v[92:107], v[188:191], v[156:159], 0
    ds_read_b64_tr_b16 v[176:177], v55 offset:10240
    ds_read_b64_tr_b16 v[178:179], v55 offset:11264
    v_mfma_f32_32x32x16_bf16 v[92:107], v[192:195], v[160:163], v[92:107]
    ds_read_b64_tr_b16 v[180:181], v57 offset:8192
    ds_read_b64_tr_b16 v[182:183], v57 offset:9216
    buffer_load_dwordx4 v24, s[68:71], s98 offen offset:2048 lds
    s_waitcnt lgkmcnt(6)
    v_mfma_f32_32x32x16_bf16 v[92:107], v[196:199], v[164:167], v[92:107]
    ds_read_b64_tr_b16 v[184:185], v57 offset:10240
    ds_read_b64_tr_b16 v[186:187], v57 offset:11264
    v_add_u32 v108, 0x10000, v108
    v_and_or_b32 v108, v108, s92, v247
    v_cvt_pk_bf16_f32 v12, v108, v109
    v_add_u32 v110, 0x10000, v110
    s_waitcnt vmcnt(17)
    s_barrier
    v_mfma_f32_32x32x16_bf16 v[92:107], v[200:203], v[168:171], v[92:107]
    ds_read_b64_tr_b16 v[156:157], v54 offset:12288
    ds_read_b64_tr_b16 v[158:159], v54 offset:13312
    buffer_load_dwordx4 v25, s[68:71], s98 offen offset:3072 lds
    v_and_or_b32 v110, v110, s92, v248
    v_cvt_pk_bf16_f32 v13, v110, v111
    v_add_u32 v112, 0x10000, v112
    v_and_or_b32 v112, v112, s92, v249
    s_waitcnt lgkmcnt(6)
    v_mfma_f32_32x32x16_bf16 v[92:107], a[112:115], v[172:175], v[92:107]
    ds_read_b64_tr_b16 v[160:161], v54 offset:14336
    ds_read_b64_tr_b16 v[162:163], v54 offset:15360
    v_cvt_pk_bf16_f32 v14, v112, v113
    v_add_u32 v114, 0x10000, v114
    v_and_or_b32 v114, v114, s92, v250
    v_cvt_pk_bf16_f32 v15, v114, v115
    v_mfma_f32_32x32x16_bf16 v[92:107], a[116:119], v[176:179], v[92:107]
    ds_read_b64_tr_b16 v[164:165], v56 offset:12288
    ds_read_b64_tr_b16 v[166:167], v56 offset:13312
    s_add_u32 m0, s82, 0x9000
    s_add_u32 s98, s39, s40
    buffer_load_dwordx4 v30, s[88:91], s98 offen lds
    v_add_u32 v116, 0x10000, v116
    v_and_or_b32 v116, v116, s92, v247
    v_cvt_pk_bf16_f32 v16, v116, v117
    v_add_u32 v118, 0x10000, v118
    s_waitcnt lgkmcnt(6)
    v_mfma_f32_32x32x16_bf16 v[92:107], a[120:123], v[180:183], v[92:107]
    ds_read_b64_tr_b16 v[168:169], v56 offset:14336
    ds_read_b64_tr_b16 v[170:171], v56 offset:15360
    v_and_or_b32 v118, v118, s92, v248
    v_cvt_pk_bf16_f32 v17, v118, v119
    v_add_u32 v120, 0x10000, v120
    v_and_or_b32 v120, v120, s92, v249
    v_mfma_f32_32x32x16_bf16 v[92:107], a[124:127], v[184:187], v[92:107]
    ds_read_b64_tr_b16 v[172:173], v55 offset:12288
    ds_read_b64_tr_b16 v[174:175], v55 offset:13312
    buffer_load_dwordx4 v31, s[88:91], s98 offen offset:1024 lds
    v_cvt_pk_bf16_f32 v18, v120, v121
    v_add_u32 v122, 0x10000, v122
    v_and_or_b32 v122, v122, s92, v250
    v_cvt_pk_bf16_f32 v19, v122, v123
    s_waitcnt lgkmcnt(6)
    v_mfma_f32_32x32x16_bf16 v[92:107], v[204:207], v[156:159], v[92:107]
    ds_read_b64_tr_b16 v[176:177], v55 offset:14336
    ds_read_b64_tr_b16 v[178:179], v55 offset:15360
    s_lshl_b32 s99, s29, 9
    buffer_store_dwordx4 v[12:15], v239, s[64:67], s99 offen sc1
    buffer_store_dwordx4 v[16:19], v239, s[64:67], s99 offen offset:1024 sc1
    v_mfma_f32_32x32x16_bf16 v[92:107], v[208:211], v[160:163], v[92:107]
    ds_read_b64_tr_b16 v[180:181], v57 offset:12288
    ds_read_b64_tr_b16 v[182:183], v57 offset:13312
    buffer_load_dwordx4 v32, s[88:91], s98 offen offset:2048 lds
    s_waitcnt lgkmcnt(6)
    v_mfma_f32_32x32x16_bf16 v[92:107], v[212:215], v[164:167], v[92:107]
    ds_read_b64_tr_b16 v[184:185], v57 offset:14336
    ds_read_b64_tr_b16 v[186:187], v57 offset:15360
    s_waitcnt vmcnt(19)
    s_barrier
    v_mfma_f32_32x32x16_bf16 v[92:107], v[216:219], v[168:171], v[92:107]
    ds_read_b128 v[156:159], v42 offset:16384
    buffer_load_dwordx4 v33, s[88:91], s98 offen offset:3072 lds
    s_waitcnt lgkmcnt(5)
    v_mfma_f32_32x32x16_bf16 v[92:107], a[128:131], v[172:175], v[92:107]
    ds_read_b128 v[160:163], v43 offset:16384
    v_mfma_f32_32x32x16_bf16 v[92:107], a[132:135], v[176:179], v[92:107]
    ds_read_b128 v[164:167], v46 offset:16384
    s_add_u32 m0, s82, 0x7000
    s_add_u32 s98, s39, s41
    buffer_load_dwordx4 v30, s[88:91], s98 offen lds
    s_waitcnt lgkmcnt(3)
    v_mfma_f32_32x32x16_bf16 v[92:107], a[136:139], v[180:183], v[92:107]
    ds_read_b128 v[168:171], v47 offset:16384
    v_mfma_f32_32x32x16_bf16 v[92:107], a[140:143], v[184:187], v[92:107]
    ds_read_b128 v[172:175], v44 offset:16384
    buffer_load_dwordx4 v31, s[88:91], s98 offen offset:1024 lds
    s_waitcnt lgkmcnt(3)
    v_mfma_f32_32x32x16_bf16 v[92:107], a[144:147], v[156:159], v[92:107]
    ds_read_b128 v[176:179], v45 offset:16384
    v_mfma_f32_32x32x16_bf16 v[92:107], a[148:151], v[160:163], v[92:107]
    ds_read_b128 v[180:183], v48 offset:16384
    buffer_load_dwordx4 v32, s[88:91], s98 offen offset:2048 lds
    s_waitcnt lgkmcnt(3)
    v_mfma_f32_32x32x16_bf16 v[92:107], a[152:155], v[164:167], v[92:107]
    ds_read_b128 v[184:187], v49 offset:16384
    s_waitcnt vmcnt(17)
    s_barrier
    v_mfma_f32_32x32x16_bf16 v[92:107], a[156:159], v[168:171], v[92:107]
    ds_read_b64_tr_b16 v[156:157], v54 offset:20480
    ds_read_b64_tr_b16 v[158:159], v54 offset:21504
    buffer_load_dwordx4 v33, s[88:91], s98 offen offset:3072 lds
    s_waitcnt lgkmcnt(4)
    v_mfma_f32_32x32x16_bf16 v[92:107], a[160:163], v[172:175], v[92:107]
    ds_read_b64_tr_b16 v[160:161], v54 offset:22528
    ds_read_b64_tr_b16 v[162:163], v54 offset:23552
    v_mfma_f32_32x32x16_bf16 v[92:107], a[164:167], v[176:179], v[92:107]
    ds_read_b64_tr_b16 v[164:165], v56 offset:20480
    ds_read_b64_tr_b16 v[166:167], v56 offset:21504
    s_add_u32 m0, s82, 0x1000
    s_mul_i32 s98, s39, 0x1c0
    buffer_load_dwordx4 v22, s[68:71], s98 offen lds
    s_waitcnt lgkmcnt(6)
    v_mfma_f32_32x32x16_bf16 v[92:107], a[168:171], v[180:183], v[92:107]
    ds_read_b64_tr_b16 v[168:169], v56 offset:22528
    ds_read_b64_tr_b16 v[170:171], v56 offset:23552
    v_mfma_f32_32x32x16_bf16 v[92:107], a[172:175], v[184:187], v[92:107]
    ds_read_b64_tr_b16 v[172:173], v55 offset:20480
    ds_read_b64_tr_b16 v[174:175], v55 offset:21504
    buffer_load_dwordx4 v23, s[68:71], s98 offen offset:1024 lds
    s_waitcnt lgkmcnt(6)
    v_mfma_f32_32x32x16_bf16 v[108:123], v[188:191], v[156:159], 0
    ds_read_b64_tr_b16 v[176:177], v55 offset:22528
    ds_read_b64_tr_b16 v[178:179], v55 offset:23552
    v_mfma_f32_32x32x16_bf16 v[108:123], v[192:195], v[160:163], v[108:123]
    ds_read_b64_tr_b16 v[180:181], v57 offset:20480
    ds_read_b64_tr_b16 v[182:183], v57 offset:21504
    buffer_load_dwordx4 v24, s[68:71], s98 offen offset:2048 lds
    s_waitcnt lgkmcnt(6)
    v_mfma_f32_32x32x16_bf16 v[108:123], v[196:199], v[164:167], v[108:123]
    ds_read_b64_tr_b16 v[184:185], v57 offset:22528
    ds_read_b64_tr_b16 v[186:187], v57 offset:23552
    v_add_u32 v92, 0x10000, v92
    v_and_or_b32 v92, v92, s92, v247
    v_cvt_pk_bf16_f32 v12, v92, v93
    v_add_u32 v94, 0x10000, v94
    s_waitcnt vmcnt(17)
    s_barrier
    v_mfma_f32_32x32x16_bf16 v[108:123], v[200:203], v[168:171], v[108:123]
    ds_read_b64_tr_b16 v[156:157], v54
    ds_read_b64_tr_b16 v[158:159], v54 offset:1024
    buffer_load_dwordx4 v25, s[68:71], s98 offen offset:3072 lds
    v_and_or_b32 v94, v94, s92, v248
    v_cvt_pk_bf16_f32 v13, v94, v95
    v_add_u32 v96, 0x10000, v96
    v_and_or_b32 v96, v96, s92, v249
    s_waitcnt lgkmcnt(6)
    v_mfma_f32_32x32x16_bf16 v[108:123], a[112:115], v[172:175], v[108:123]
    ds_read_b64_tr_b16 v[160:161], v54 offset:2048
    ds_read_b64_tr_b16 v[162:163], v54 offset:3072
    v_cvt_pk_bf16_f32 v14, v96, v97
    v_add_u32 v98, 0x10000, v98
    v_and_or_b32 v98, v98, s92, v250
    v_cvt_pk_bf16_f32 v15, v98, v99
    v_mfma_f32_32x32x16_bf16 v[108:123], a[116:119], v[176:179], v[108:123]
    ds_read_b64_tr_b16 v[164:165], v56
    ds_read_b64_tr_b16 v[166:167], v56 offset:1024
    v_add_u32 v100, 0x10000, v100
    v_and_or_b32 v100, v100, s92, v247
    v_cvt_pk_bf16_f32 v16, v100, v101
    v_add_u32 v102, 0x10000, v102
    s_waitcnt lgkmcnt(6)
    v_mfma_f32_32x32x16_bf16 v[108:123], a[120:123], v[180:183], v[108:123]
    ds_read_b64_tr_b16 v[168:169], v56 offset:2048
    ds_read_b64_tr_b16 v[170:171], v56 offset:3072
    v_and_or_b32 v102, v102, s92, v248
    v_cvt_pk_bf16_f32 v17, v102, v103
    v_add_u32 v104, 0x10000, v104
    v_and_or_b32 v104, v104, s92, v249
    v_mfma_f32_32x32x16_bf16 v[108:123], a[124:127], v[184:187], v[108:123]
    ds_read_b64_tr_b16 v[172:173], v55
    ds_read_b64_tr_b16 v[174:175], v55 offset:1024
    v_cvt_pk_bf16_f32 v18, v104, v105
    v_add_u32 v106, 0x10000, v106
    v_and_or_b32 v106, v106, s92, v250
    v_cvt_pk_bf16_f32 v19, v106, v107
    s_waitcnt lgkmcnt(6)
    v_mfma_f32_32x32x16_bf16 v[108:123], v[204:207], v[156:159], v[108:123]
    ds_read_b64_tr_b16 v[176:177], v55 offset:2048
    ds_read_b64_tr_b16 v[178:179], v55 offset:3072
    s_lshl_b32 s99, s37, 9
    buffer_store_dwordx4 v[12:15], v239, s[64:67], s99 offen sc1
    buffer_store_dwordx4 v[16:19], v239, s[64:67], s99 offen offset:1024 sc1
    v_mfma_f32_32x32x16_bf16 v[108:123], v[208:211], v[160:163], v[108:123]
    ds_read_b64_tr_b16 v[180:181], v57
    ds_read_b64_tr_b16 v[182:183], v57 offset:1024
    s_waitcnt lgkmcnt(6)
    v_mfma_f32_32x32x16_bf16 v[108:123], v[212:215], v[164:167], v[108:123]
    ds_read_b64_tr_b16 v[184:185], v57 offset:2048
    ds_read_b64_tr_b16 v[186:187], v57 offset:3072
    s_waitcnt vmcnt(16)
    s_barrier
    v_mfma_f32_32x32x16_bf16 v[108:123], v[216:219], v[168:171], v[108:123]
    ds_read_b128 v[156:159], v42 offset:32768
    s_waitcnt lgkmcnt(5)
    v_mfma_f32_32x32x16_bf16 v[108:123], a[128:131], v[172:175], v[108:123]
    ds_read_b128 v[160:163], v43 offset:32768
    v_mfma_f32_32x32x16_bf16 v[108:123], a[132:135], v[176:179], v[108:123]
    ds_read_b128 v[164:167], v46 offset:32768
    s_waitcnt lgkmcnt(3)
    v_mfma_f32_32x32x16_bf16 v[108:123], a[136:139], v[180:183], v[108:123]
    ds_read_b128 v[168:171], v47 offset:32768
    v_mfma_f32_32x32x16_bf16 v[108:123], a[140:143], v[184:187], v[108:123]
    ds_read_b128 v[172:175], v44 offset:32768
    s_waitcnt lgkmcnt(3)
    v_mfma_f32_32x32x16_bf16 v[108:123], a[144:147], v[156:159], v[108:123]
    ds_read_b128 v[176:179], v45 offset:32768
    v_mfma_f32_32x32x16_bf16 v[108:123], a[148:151], v[160:163], v[108:123]
    ds_read_b128 v[180:183], v48 offset:32768
    s_waitcnt lgkmcnt(3)
    v_mfma_f32_32x32x16_bf16 v[108:123], a[152:155], v[164:167], v[108:123]
    ds_read_b128 v[184:187], v49 offset:32768
    s_waitcnt vmcnt(10)
    s_barrier
    v_mfma_f32_32x32x16_bf16 v[108:123], a[156:159], v[168:171], v[108:123]
    ds_read_b64_tr_b16 v[156:157], v54 offset:36864
    ds_read_b64_tr_b16 v[158:159], v54 offset:37888
    s_waitcnt lgkmcnt(4)
    v_mfma_f32_32x32x16_bf16 v[108:123], a[160:163], v[172:175], v[108:123]
    ds_read_b64_tr_b16 v[160:161], v54 offset:38912
    ds_read_b64_tr_b16 v[162:163], v54 offset:39936
    v_mfma_f32_32x32x16_bf16 v[108:123], a[164:167], v[176:179], v[108:123]
    ds_read_b64_tr_b16 v[164:165], v56 offset:36864
    ds_read_b64_tr_b16 v[166:167], v56 offset:37888
    s_waitcnt lgkmcnt(6)
    v_mfma_f32_32x32x16_bf16 v[108:123], a[168:171], v[180:183], v[108:123]
    ds_read_b64_tr_b16 v[168:169], v56 offset:38912
    ds_read_b64_tr_b16 v[170:171], v56 offset:39936
    v_mfma_f32_32x32x16_bf16 v[108:123], a[172:175], v[184:187], v[108:123]
    ds_read_b64_tr_b16 v[172:173], v55 offset:36864
    ds_read_b64_tr_b16 v[174:175], v55 offset:37888
    s_waitcnt lgkmcnt(6)
    v_mfma_f32_32x32x16_bf16 v[124:139], v[188:191], v[156:159], v[124:139]
    ds_read_b64_tr_b16 v[176:177], v55 offset:38912
    ds_read_b64_tr_b16 v[178:179], v55 offset:39936
    v_mfma_f32_32x32x16_bf16 v[124:139], v[192:195], v[160:163], v[124:139]
    ds_read_b64_tr_b16 v[180:181], v57 offset:36864
    ds_read_b64_tr_b16 v[182:183], v57 offset:37888
    s_waitcnt lgkmcnt(6)
    v_mfma_f32_32x32x16_bf16 v[124:139], v[196:199], v[164:167], v[124:139]
    ds_read_b64_tr_b16 v[184:185], v57 offset:38912
    ds_read_b64_tr_b16 v[186:187], v57 offset:39936
    v_add_u32 v108, 0x10000, v108
    v_and_or_b32 v108, v108, s92, v247
    v_cvt_pk_bf16_f32 v12, v108, v109
    v_add_u32 v110, 0x10000, v110
    s_waitcnt vmcnt(6)
    s_barrier
    v_mfma_f32_32x32x16_bf16 v[124:139], v[200:203], v[168:171], v[124:139]
    ds_read_b64_tr_b16 v[156:157], v54 offset:28672
    ds_read_b64_tr_b16 v[158:159], v54 offset:29696
    v_and_or_b32 v110, v110, s92, v248
    v_cvt_pk_bf16_f32 v13, v110, v111
    v_add_u32 v112, 0x10000, v112
    v_and_or_b32 v112, v112, s92, v249
    s_waitcnt lgkmcnt(6)
    v_mfma_f32_32x32x16_bf16 v[124:139], a[112:115], v[172:175], v[124:139]
    ds_read_b64_tr_b16 v[160:161], v54 offset:30720
    ds_read_b64_tr_b16 v[162:163], v54 offset:31744
    v_cvt_pk_bf16_f32 v14, v112, v113
    v_add_u32 v114, 0x10000, v114
    v_and_or_b32 v114, v114, s92, v250
    v_cvt_pk_bf16_f32 v15, v114, v115
    v_mfma_f32_32x32x16_bf16 v[124:139], a[116:119], v[176:179], v[124:139]
    ds_read_b64_tr_b16 v[164:165], v56 offset:28672
    ds_read_b64_tr_b16 v[166:167], v56 offset:29696
    v_add_u32 v116, 0x10000, v116
    v_and_or_b32 v116, v116, s92, v247
    v_cvt_pk_bf16_f32 v16, v116, v117
    v_add_u32 v118, 0x10000, v118
    s_waitcnt lgkmcnt(6)
    v_mfma_f32_32x32x16_bf16 v[124:139], a[120:123], v[180:183], v[124:139]
    ds_read_b64_tr_b16 v[168:169], v56 offset:30720
    ds_read_b64_tr_b16 v[170:171], v56 offset:31744
    v_and_or_b32 v118, v118, s92, v248
    v_cvt_pk_bf16_f32 v17, v118, v119
    v_add_u32 v120, 0x10000, v120
    v_and_or_b32 v120, v120, s92, v249
    v_mfma_f32_32x32x16_bf16 v[124:139], a[124:127], v[184:187], v[124:139]
    ds_read_b64_tr_b16 v[172:173], v55 offset:28672
    ds_read_b64_tr_b16 v[174:175], v55 offset:29696
    v_cvt_pk_bf16_f32 v18, v120, v121
    v_add_u32 v122, 0x10000, v122
    v_and_or_b32 v122, v122, s92, v250
    v_cvt_pk_bf16_f32 v19, v122, v123
    s_waitcnt lgkmcnt(6)
    v_mfma_f32_32x32x16_bf16 v[124:139], v[204:207], v[156:159], v[124:139]
    ds_read_b64_tr_b16 v[176:177], v55 offset:30720
    ds_read_b64_tr_b16 v[178:179], v55 offset:31744
    s_lshl_b32 s99, s38, 9
    buffer_store_dwordx4 v[12:15], v239, s[64:67], s99 offen sc1
    buffer_store_dwordx4 v[16:19], v239, s[64:67], s99 offen offset:1024 sc1
    v_mfma_f32_32x32x16_bf16 v[124:139], v[208:211], v[160:163], v[124:139]
    ds_read_b64_tr_b16 v[180:181], v57 offset:28672
    ds_read_b64_tr_b16 v[182:183], v57 offset:29696
    s_waitcnt lgkmcnt(6)
    v_mfma_f32_32x32x16_bf16 v[124:139], v[212:215], v[164:167], v[124:139]
    ds_read_b64_tr_b16 v[184:185], v57 offset:30720
    ds_read_b64_tr_b16 v[186:187], v57 offset:31744
    s_lshl_b32 s99, s93, 6
    buffer_load_dwordx4 v[60:63], v240, s[64:67], s99 offen sc1
    buffer_load_dwordx4 v[64:67], v240, s[64:67], s99 offen offset:1024 sc1
    s_waitcnt vmcnt(6)
    s_barrier
    v_mfma_f32_32x32x16_bf16 v[124:139], v[216:219], v[168:171], v[124:139]
    ds_read_b128 v[156:159], v42 offset:4096
    s_waitcnt lgkmcnt(5)
    v_mfma_f32_32x32x16_bf16 v[124:139], a[128:131], v[172:175], v[124:139]
    ds_read_b128 v[160:163], v43 offset:4096
    v_mfma_f32_32x32x16_bf16 v[124:139], a[132:135], v[176:179], v[124:139]
    ds_read_b128 v[164:167], v46 offset:4096
    s_lshl_b32 s99, s94, 6
    buffer_load_dwordx4 v[68:71], v240, s[64:67], s99 offen sc1
    buffer_load_dwordx4 v[72:75], v240, s[64:67], s99 offen offset:1024 sc1
    s_waitcnt lgkmcnt(3)
    v_mfma_f32_32x32x16_bf16 v[124:139], a[136:139], v[180:183], v[124:139]
    ds_read_b128 v[168:171], v47 offset:4096
    v_mfma_f32_32x32x16_bf16 v[124:139], a[140:143], v[184:187], v[124:139]
    ds_read_b128 v[172:175], v44 offset:4096
    s_waitcnt lgkmcnt(3)
    v_mfma_f32_32x32x16_bf16 v[124:139], a[144:147], v[156:159], v[124:139]
    ds_read_b128 v[176:179], v45 offset:4096
    s_lshl_b32 s99, s95, 6
    buffer_load_dwordx4 v[76:79], v240, s[64:67], s99 offen sc1
    buffer_load_dwordx4 v[80:83], v240, s[64:67], s99 offen offset:1024 sc1
    v_mfma_f32_32x32x16_bf16 v[124:139], a[148:151], v[160:163], v[124:139]
    ds_read_b128 v[180:183], v48 offset:4096
    s_waitcnt lgkmcnt(3)
    v_mfma_f32_32x32x16_bf16 v[124:139], a[152:155], v[164:167], v[124:139]
    ds_read_b128 v[184:187], v49 offset:4096
    v_mfma_f32_32x32x16_bf16 v[124:139], a[156:159], v[168:171], v[124:139]
    s_lshl_b32 s99, s96, 6
    buffer_load_dwordx4 v[84:87], v240, s[64:67], s99 offen sc1
    buffer_load_dwordx4 v[88:91], v240, s[64:67], s99 offen offset:1024 sc1
    s_waitcnt lgkmcnt(2)
    v_mfma_f32_32x32x16_bf16 v[124:139], a[160:163], v[172:175], v[124:139]
    v_mfma_f32_32x32x16_bf16 v[124:139], a[164:167], v[176:179], v[124:139]
    s_waitcnt lgkmcnt(0)
    v_mfma_f32_32x32x16_bf16 v[124:139], a[168:171], v[180:183], v[124:139]
    v_mfma_f32_32x32x16_bf16 v[124:139], a[172:175], v[184:187], v[124:139]
    s_lshl_b32 s99, s97, 6
    buffer_load_dwordx4 v[156:159], v240, s[64:67], s99 offen sc1
    buffer_load_dwordx4 v[160:163], v240, s[64:67], s99 offen offset:1024 sc1
    s_lshl_b32 s99, s86, 6
    buffer_load_dwordx4 v[164:167], v240, s[64:67], s99 offen sc1
    buffer_load_dwordx4 v[168:171], v240, s[64:67], s99 offen offset:1024 sc1
    s_waitcnt vmcnt(11)
    v_xor_b32 v60, v60, v4
    v_xor_b32 v61, v61, v5
    v_or_b32 v11, v60, v61
    v_xor_b32 v62, v62, v6
    v_xor_b32 v63, v63, v7
    v_or3_b32 v11, v62, v63, v11
    s_waitcnt vmcnt(10)
    v_xor_b32 v64, v64, v4
    v_xor_b32 v65, v65, v5
    v_or3_b32 v11, v64, v65, v11
    v_xor_b32 v66, v66, v6
    v_xor_b32 v67, v67, v7
    v_or3_b32 v11, v66, v67, v11
    v_and_b32 v11, 1, v11
    v_cmp_ne_u32 vcc, 0, v11
    s_nop 0
    s_cmp_lg_u64 vcc, 0
    s_cbranch_scc1 SPIN_5
RES_6:
    v_lshlrev_b32 v12, 16, v60
    v_and_b32 v13, 0xffff0000, v60
    v_pk_add_f32 v[124:125], v[124:125], v[12:13]
    v_lshlrev_b32 v14, 16, v61
    v_and_b32 v15, 0xffff0000, v61
    v_pk_add_f32 v[126:127], v[126:127], v[14:15]
    v_lshlrev_b32 v12, 16, v62
    v_and_b32 v13, 0xffff0000, v62
    v_pk_add_f32 v[128:129], v[128:129], v[12:13]
    v_lshlrev_b32 v14, 16, v63
    v_and_b32 v15, 0xffff0000, v63
    v_pk_add_f32 v[130:131], v[130:131], v[14:15]
    v_lshlrev_b32 v12, 16, v64
    v_and_b32 v13, 0xffff0000, v64
    v_pk_add_f32 v[132:133], v[132:133], v[12:13]
    v_lshlrev_b32 v14, 16, v65
    v_and_b32 v15, 0xffff0000, v65
    v_pk_add_f32 v[134:135], v[134:135], v[14:15]
    v_lshlrev_b32 v12, 16, v66
    v_and_b32 v13, 0xffff0000, v66
    v_pk_add_f32 v[136:137], v[136:137], v[12:13]
    v_lshlrev_b32 v14, 16, v67
    v_and_b32 v15, 0xffff0000, v67
    v_pk_add_f32 v[138:139], v[138:139], v[14:15]
    s_waitcnt vmcnt(9)
    v_xor_b32 v68, v68, v4
    v_xor_b32 v69, v69, v5
    v_or_b32 v11, v68, v69
    v_xor_b32 v70, v70, v6
    v_xor_b32 v71, v71, v7
    v_or3_b32 v11, v70, v71, v11
    s_waitcnt vmcnt(8)
    v_xor_b32 v72, v72, v4
    v_xor_b32 v73, v73, v5
    v_or3_b32 v11, v72, v73, v11
    v_xor_b32 v74, v74, v6
    v_xor_b32 v75, v75, v7
    v_or3_b32 v11, v74, v75, v11
    v_and_b32 v11, 1, v11
    v_cmp_ne_u32 vcc, 0, v11
    s_nop 0
    s_cmp_lg_u64 vcc, 0
    s_cbranch_scc1 SPIN_7
RES_8:
    v_lshlrev_b32 v12, 16, v68
    v_and_b32 v13, 0xffff0000, v68
    v_pk_add_f32 v[124:125], v[124:125], v[12:13]
    v_lshlrev_b32 v14, 16, v69
    v_and_b32 v15, 0xffff0000, v69
    v_pk_add_f32 v[126:127], v[126:127], v[14:15]
    v_lshlrev_b32 v12, 16, v70
    v_and_b32 v13, 0xffff0000, v70
    v_pk_add_f32 v[128:129], v[128:129], v[12:13]
    v_lshlrev_b32 v14, 16, v71
    v_and_b32 v15, 0xffff0000, v71
    v_pk_add_f32 v[130:131], v[130:131], v[14:15]
    v_lshlrev_b32 v12, 16, v72
    v_and_b32 v13, 0xffff0000, v72
    v_pk_add_f32 v[132:133], v[132:133], v[12:13]
    v_lshlrev_b32 v14, 16, v73
    v_and_b32 v15, 0xffff0000, v73
    v_pk_add_f32 v[134:135], v[134:135], v[14:15]
    v_lshlrev_b32 v12, 16, v74
    v_and_b32 v13, 0xffff0000, v74
    v_pk_add_f32 v[136:137], v[136:137], v[12:13]
    v_lshlrev_b32 v14, 16, v75
    v_and_b32 v15, 0xffff0000, v75
    v_pk_add_f32 v[138:139], v[138:139], v[14:15]
    s_waitcnt vmcnt(7)
    v_xor_b32 v76, v76, v4
    v_xor_b32 v77, v77, v5
    v_or_b32 v11, v76, v77
    v_xor_b32 v78, v78, v6
    v_xor_b32 v79, v79, v7
    v_or3_b32 v11, v78, v79, v11
    s_waitcnt vmcnt(6)
    v_xor_b32 v80, v80, v4
    v_xor_b32 v81, v81, v5
    v_or3_b32 v11, v80, v81, v11
    v_xor_b32 v82, v82, v6
    v_xor_b32 v83, v83, v7
    v_or3_b32 v11, v82, v83, v11
    v_and_b32 v11, 1, v11
    v_cmp_ne_u32 vcc, 0, v11
    s_nop 0
    s_cmp_lg_u64 vcc, 0
    s_cbranch_scc1 SPIN_9
RES_10:
    v_lshlrev_b32 v12, 16, v76
    v_and_b32 v13, 0xffff0000, v76
    v_pk_add_f32 v[124:125], v[124:125], v[12:13]
    v_lshlrev_b32 v14, 16, v77
    v_and_b32 v15, 0xffff0000, v77
    v_pk_add_f32 v[126:127], v[126:127], v[14:15]
    v_lshlrev_b32 v12, 16, v78
    v_and_b32 v13, 0xffff0000, v78
    v_pk_add_f32 v[128:129], v[128:129], v[12:13]
    v_lshlrev_b32 v14, 16, v79
    v_and_b32 v15, 0xffff0000, v79
    v_pk_add_f32 v[130:131], v[130:131], v[14:15]
    v_lshlrev_b32 v12, 16, v80
    v_and_b32 v13, 0xffff0000, v80
    v_pk_add_f32 v[132:133], v[132:133], v[12:13]
    v_lshlrev_b32 v14, 16, v81
    v_and_b32 v15, 0xffff0000, v81
    v_pk_add_f32 v[134:135], v[134:135], v[14:15]
    v_lshlrev_b32 v12, 16, v82
    v_and_b32 v13, 0xffff0000, v82
    v_pk_add_f32 v[136:137], v[136:137], v[12:13]
    v_lshlrev_b32 v14, 16, v83
    v_and_b32 v15, 0xffff0000, v83
    v_pk_add_f32 v[138:139], v[138:139], v[14:15]
    s_waitcnt vmcnt(5)
    v_xor_b32 v84, v84, v4
    v_xor_b32 v85, v85, v5
    v_or_b32 v11, v84, v85
    v_xor_b32 v86, v86, v6
    v_xor_b32 v87, v87, v7
    v_or3_b32 v11, v86, v87, v11
    s_waitcnt vmcnt(4)
    v_xor_b32 v88, v88, v4
    v_xor_b32 v89, v89, v5
    v_or3_b32 v11, v88, v89, v11
    v_xor_b32 v90, v90, v6
    v_xor_b32 v91, v91, v7
    v_or3_b32 v11, v90, v91, v11
    v_and_b32 v11, 1, v11
    v_cmp_ne_u32 vcc, 0, v11
    s_nop 0
    s_cmp_lg_u64 vcc, 0
    s_cbranch_scc1 SPIN_11
RES_12:
    v_lshlrev_b32 v12, 16, v84
    v_and_b32 v13, 0xffff0000, v84
    v_pk_add_f32 v[124:125], v[124:125], v[12:13]
    v_lshlrev_b32 v14, 16, v85
    v_and_b32 v15, 0xffff0000, v85
    v_pk_add_f32 v[126:127], v[126:127], v[14:15]
    v_lshlrev_b32 v12, 16, v86
    v_and_b32 v13, 0xffff0000, v86
    v_pk_add_f32 v[128:129], v[128:129], v[12:13]
    v_lshlrev_b32 v14, 16, v87
    v_and_b32 v15, 0xffff0000, v87
    v_pk_add_f32 v[130:131], v[130:131], v[14:15]
    v_lshlrev_b32 v12, 16, v88
    v_and_b32 v13, 0xffff0000, v88
    v_pk_add_f32 v[132:133], v[132:133], v[12:13]
    v_lshlrev_b32 v14, 16, v89
    v_and_b32 v15, 0xffff0000, v89
    v_pk_add_f32 v[134:135], v[134:135], v[14:15]
    v_lshlrev_b32 v12, 16, v90
    v_and_b32 v13, 0xffff0000, v90
    v_pk_add_f32 v[136:137], v[136:137], v[12:13]
    v_lshlrev_b32 v14, 16, v91
    v_and_b32 v15, 0xffff0000, v91
    v_pk_add_f32 v[138:139], v[138:139], v[14:15]
    s_waitcnt vmcnt(3)
    v_xor_b32 v156, v156, v4
    v_xor_b32 v157, v157, v5
    v_or_b32 v11, v156, v157
    v_xor_b32 v158, v158, v6
    v_xor_b32 v159, v159, v7
    v_or3_b32 v11, v158, v159, v11
    s_waitcnt vmcnt(2)
    v_xor_b32 v160, v160, v4
    v_xor_b32 v161, v161, v5
    v_or3_b32 v11, v160, v161, v11
    v_xor_b32 v162, v162, v6
    v_xor_b32 v163, v163, v7
    v_or3_b32 v11, v162, v163, v11
    v_and_b32 v11, 1, v11
    v_cmp_ne_u32 vcc, 0, v11
    s_nop 0
    s_cmp_lg_u64 vcc, 0
    s_cbranch_scc1 SPIN_13
RES_14:
    v_lshlrev_b32 v12, 16, v156
    v_and_b32 v13, 0xffff0000, v156
    v_pk_add_f32 v[124:125], v[124:125], v[12:13]
    v_lshlrev_b32 v14, 16, v157
    v_and_b32 v15, 0xffff0000, v157
    v_pk_add_f32 v[126:127], v[126:127], v[14:15]
    v_lshlrev_b32 v12, 16, v158
    v_and_b32 v13, 0xffff0000, v158
    v_pk_add_f32 v[128:129], v[128:129], v[12:13]
    v_lshlrev_b32 v14, 16, v159
    v_and_b32 v15, 0xffff0000, v159
    v_pk_add_f32 v[130:131], v[130:131], v[14:15]
    v_lshlrev_b32 v12, 16, v160
    v_and_b32 v13, 0xffff0000, v160
    v_pk_add_f32 v[132:133], v[132:133], v[12:13]
    v_lshlrev_b32 v14, 16, v161
    v_and_b32 v15, 0xffff0000, v161
    v_pk_add_f32 v[134:135], v[134:135], v[14:15]
    v_lshlrev_b32 v12, 16, v162
    v_and_b32 v13, 0xffff0000, v162
    v_pk_add_f32 v[136:137], v[136:137], v[12:13]
    v_lshlrev_b32 v14, 16, v163
    v_and_b32 v15, 0xffff0000, v163
    v_pk_add_f32 v[138:139], v[138:139], v[14:15]
    s_waitcnt vmcnt(1)
    v_xor_b32 v164, v164, v4
    v_xor_b32 v165, v165, v5
    v_or_b32 v11, v164, v165
    v_xor_b32 v166, v166, v6
    v_xor_b32 v167, v167, v7
    v_or3_b32 v11, v166, v167, v11
    s_waitcnt vmcnt(0)
    v_xor_b32 v168, v168, v4
    v_xor_b32 v169, v169, v5
    v_or3_b32 v11, v168, v169, v11
    v_xor_b32 v170, v170, v6
    v_xor_b32 v171, v171, v7
    v_or3_b32 v11, v170, v171, v11
    v_and_b32 v11, 1, v11
    v_cmp_ne_u32 vcc, 0, v11
    s_nop 0
    s_cmp_lg_u64 vcc, 0
    s_cbranch_scc1 SPIN_15
RES_16:
    v_lshlrev_b32 v12, 16, v164
    v_and_b32 v13, 0xffff0000, v164
    v_pk_add_f32 v[124:125], v[124:125], v[12:13]
    v_lshlrev_b32 v14, 16, v165
    v_and_b32 v15, 0xffff0000, v165
    v_pk_add_f32 v[126:127], v[126:127], v[14:15]
    v_lshlrev_b32 v12, 16, v166
    v_and_b32 v13, 0xffff0000, v166
    v_pk_add_f32 v[128:129], v[128:129], v[12:13]
    v_lshlrev_b32 v14, 16, v167
    v_and_b32 v15, 0xffff0000, v167
    v_pk_add_f32 v[130:131], v[130:131], v[14:15]
    v_lshlrev_b32 v12, 16, v168
    v_and_b32 v13, 0xffff0000, v168
    v_pk_add_f32 v[132:133], v[132:133], v[12:13]
    v_lshlrev_b32 v14, 16, v169
    v_and_b32 v15, 0xffff0000, v169
    v_pk_add_f32 v[134:135], v[134:135], v[14:15]
    v_lshlrev_b32 v12, 16, v170
    v_and_b32 v13, 0xffff0000, v170
    v_pk_add_f32 v[136:137], v[136:137], v[12:13]
    v_lshlrev_b32 v14, 16, v171
    v_and_b32 v15, 0xffff0000, v171
    v_pk_add_f32 v[138:139], v[138:139], v[14:15]
    s_movk_i32 s99, 0
    buffer_store_dword v124, v236, s[72:75], s99 offen sc1
    buffer_store_dword v125, v236, s[72:75], s99 offen offset:1792 sc1
    s_movk_i32 s99, 0xe00
    buffer_store_dword v126, v236, s[72:75], s99 offen sc1
    buffer_store_dword v127, v236, s[72:75], s99 offen offset:1792 sc1
    s_movk_i32 s99, 0x1c00
    buffer_store_dword v128, v236, s[72:75], s99 offen sc1
    buffer_store_dword v129, v236, s[72:75], s99 offen offset:1792 sc1
    s_movk_i32 s99, 0x2a00
    buffer_store_dword v130, v236, s[72:75], s99 offen sc1
    buffer_store_dword v131, v236, s[72:75], s99 offen offset:1792 sc1
    s_movk_i32 s99, 0x3800
    buffer_store_dword v132, v236, s[72:75], s99 offen sc1
    buffer_store_dword v133, v236, s[72:75], s99 offen offset:1792 sc1
    s_movk_i32 s99, 0x4600
    buffer_store_dword v134, v236, s[72:75], s99 offen sc1
    buffer_store_dword v135, v236, s[72:75], s99 offen offset:1792 sc1
    s_movk_i32 s99, 0x5400
    buffer_store_dword v136, v236, s[72:75], s99 offen sc1
    buffer_store_dword v137, v236, s[72:75], s99 offen offset:1792 sc1
    s_movk_i32 s99, 0x6200
    buffer_store_dword v138, v236, s[72:75], s99 offen sc1
    buffer_store_dword v139, v236, s[72:75], s99 offen offset:1792 sc1
    s_endpgm
L_HELPER:
    s_bfe_u32 s6, s2, 0x20003
    s_lshl_b32 s6, s6, 13
    v_lshl_add_u32 v9, v0, 4, s6
    global_load_dwordx4 v[4:7], v9, s[4:5]
    v_add_u32 v10, 0x1000, v9
    global_load_dwordx4 v[16:19], v10, s[4:5]
    v_and_b32 v11, 7, v1
    v_lshlrev_b32 v11, 4, v11
    s_lshl_b32 s9, s2, 6
    s_lshl_b32 s10, s3, 4
    s_add_u32 s9, s9, s10
    v_lshrrev_b32 v105, 3, v1
    v_add_u32 v105, s9, v105
    v_mul_u32_u24 v104, 0x380, v105
    v_add_u32 v104, v104, v11
    s_waitcnt lgkmcnt(0)
    s_mov_b32 s64, s48
    s_mov_b32 s65, s49
    s_mov_b32 s66, 0xf80000
    s_mov_b32 s67, 0x20000
    s_mov_b32 s52, s16
    s_mov_b32 s53, s17
    s_mov_b32 s54, 0x1c0000
    s_mov_b32 s55, 0x20000
    s_and_b32 s9, s2, 7
    s_mul_i32 s9, s9, 28
    s_bfe_u32 s10, s2, 0x10004
    s_mul_i32 s10, s10, 27
    s_add_u32 s9, s9, s10
    s_lshr_b32 s86, s9, 5
    s_bfe_u32 s87, s2, 0x10003
    s_movk_i32 s98, 0x1c00
    global_load_dwordx4 v[20:23], v11, s[42:43] offset:0
    buffer_load_dwordx4 v[48:51], v104, s[52:55], 0 offen
    buffer_load_dwordx4 v[76:79], v104, s[52:55], s98 offen
    global_load_dwordx4 v[24:27], v11, s[42:43] offset:128
    buffer_load_dwordx4 v[52:55], v104, s[52:55], 0 offen offset:128
    buffer_load_dwordx4 v[80:83], v104, s[52:55], s98 offen offset:128
    global_load_dwordx4 v[28:31], v11, s[42:43] offset:256
    buffer_load_dwordx4 v[56:59], v104, s[52:55], 0 offen offset:256
    buffer_load_dwordx4 v[84:87], v104, s[52:55], s98 offen offset:256
    global_load_dwordx4 v[32:35], v11, s[42:43] offset:384
    buffer_load_dwordx4 v[60:63], v104, s[52:55], 0 offen offset:384
    buffer_load_dwordx4 v[88:91], v104, s[52:55], s98 offen offset:384
    global_load_dwordx4 v[36:39], v11, s[42:43] offset:512
    buffer_load_dwordx4 v[64:67], v104, s[52:55], 0 offen offset:512
    buffer_load_dwordx4 v[92:95], v104, s[52:55], s98 offen offset:512
    global_load_dwordx4 v[40:43], v11, s[42:43] offset:640
    buffer_load_dwordx4 v[68:71], v104, s[52:55], 0 offen offset:640
    buffer_load_dwordx4 v[96:99], v104, s[52:55], s98 offen offset:640
    global_load_dwordx4 v[44:47], v11, s[42:43] offset:768
    buffer_load_dwordx4 v[72:75], v104, s[52:55], 0 offen offset:768
    buffer_load_dwordx4 v[100:103], v104, s[52:55], s98 offen offset:768
    v_mov_b32 v106, 0xf08000
    buffer_load_dword v106, v106, s[64:67], 0 offen
    s_min_u32 s81, s2, 13
    s_lshl_b32 s9, s81, 5
    v_and_b32 v8, 31, v1
    v_add_lshl_u32 v8, v8, s9, 1
    global_load_ushort v107, v8, s[18:19]
    global_load_ushort v108, v8, s[20:21]
    global_load_ushort v109, v8, s[30:31]
    v_mov_b32 v112, 0
    v_mov_b32 v113, 0
    v_mov_b32 v114, 0
    v_mov_b32 v115, 0
    s_mov_b32 s13, 0x3f803f80
    s_waitcnt vmcnt(24)
    v_lshlrev_b32 v8, 16, v20
    v_and_b32 v9, 0xffff0000, v20
    s_waitcnt vmcnt(23)
    v_lshlrev_b32 v10, 16, v48
    v_and_b32 v11, 0xffff0000, v48
    v_pk_mul_f32 v[10:11], v[10:11], v[8:9]
    v_cvt_pk_bf16_f32 v10, v10, v11
    v_dot2_f32_bf16 v112, v10, s13, v112
    s_waitcnt vmcnt(22)
    v_lshlrev_b32 v12, 16, v76
    v_and_b32 v13, 0xffff0000, v76
    v_pk_mul_f32 v[12:13], v[12:13], v[8:9]
    v_cvt_pk_bf16_f32 v12, v12, v13
    v_dot2_f32_bf16 v114, v12, s13, v114
    v_lshlrev_b32 v8, 16, v21
    v_and_b32 v9, 0xffff0000, v21
    v_lshlrev_b32 v10, 16, v49
    v_and_b32 v11, 0xffff0000, v49
    v_pk_mul_f32 v[10:11], v[10:11], v[8:9]
    v_cvt_pk_bf16_f32 v10, v10, v11
    v_dot2_f32_bf16 v113, v10, s13, v113
    v_lshlrev_b32 v12, 16, v77
    v_and_b32 v13, 0xffff0000, v77
    v_pk_mul_f32 v[12:13], v[12:13], v[8:9]
    v_cvt_pk_bf16_f32 v12, v12, v13
    v_dot2_f32_bf16 v115, v12, s13, v115
    v_lshlrev_b32 v8, 16, v22
    v_and_b32 v9, 0xffff0000, v22
    v_lshlrev_b32 v10, 16, v50
    v_and_b32 v11, 0xffff0000, v50
    v_pk_mul_f32 v[10:11], v[10:11], v[8:9]
    v_cvt_pk_bf16_f32 v10, v10, v11
    v_dot2_f32_bf16 v112, v10, s13, v112
    v_lshlrev_b32 v12, 16, v78
    v_and_b32 v13, 0xffff0000, v78
    v_pk_mul_f32 v[12:13], v[12:13], v[8:9]
    v_cvt_pk_bf16_f32 v12, v12, v13
    v_dot2_f32_bf16 v114, v12, s13, v114
    v_lshlrev_b32 v8, 16, v23
    v_and_b32 v9, 0xffff0000, v23
    v_lshlrev_b32 v10, 16, v51
    v_and_b32 v11, 0xffff0000, v51
    v_pk_mul_f32 v[10:11], v[10:11], v[8:9]
    v_cvt_pk_bf16_f32 v10, v10, v11
    v_dot2_f32_bf16 v113, v10, s13, v113
    v_lshlrev_b32 v12, 16, v79
    v_and_b32 v13, 0xffff0000, v79
    v_pk_mul_f32 v[12:13], v[12:13], v[8:9]
    v_cvt_pk_bf16_f32 v12, v12, v13
    v_dot2_f32_bf16 v115, v12, s13, v115
    s_waitcnt vmcnt(21)
    v_lshlrev_b32 v8, 16, v24
    v_and_b32 v9, 0xffff0000, v24
    s_waitcnt vmcnt(20)
    v_lshlrev_b32 v10, 16, v52
    v_and_b32 v11, 0xffff0000, v52
    v_pk_mul_f32 v[10:11], v[10:11], v[8:9]
    v_cvt_pk_bf16_f32 v10, v10, v11
    v_dot2_f32_bf16 v112, v10, s13, v112
    s_waitcnt vmcnt(19)
    v_lshlrev_b32 v12, 16, v80
    v_and_b32 v13, 0xffff0000, v80
    v_pk_mul_f32 v[12:13], v[12:13], v[8:9]
    v_cvt_pk_bf16_f32 v12, v12, v13
    v_dot2_f32_bf16 v114, v12, s13, v114
    v_lshlrev_b32 v8, 16, v25
    v_and_b32 v9, 0xffff0000, v25
    v_lshlrev_b32 v10, 16, v53
    v_and_b32 v11, 0xffff0000, v53
    v_pk_mul_f32 v[10:11], v[10:11], v[8:9]
    v_cvt_pk_bf16_f32 v10, v10, v11
    v_dot2_f32_bf16 v113, v10, s13, v113
    v_lshlrev_b32 v12, 16, v81
    v_and_b32 v13, 0xffff0000, v81
    v_pk_mul_f32 v[12:13], v[12:13], v[8:9]
    v_cvt_pk_bf16_f32 v12, v12, v13
    v_dot2_f32_bf16 v115, v12, s13, v115
    v_lshlrev_b32 v8, 16, v26
    v_and_b32 v9, 0xffff0000, v26
    v_lshlrev_b32 v10, 16, v54
    v_and_b32 v11, 0xffff0000, v54
    v_pk_mul_f32 v[10:11], v[10:11], v[8:9]
    v_cvt_pk_bf16_f32 v10, v10, v11
    v_dot2_f32_bf16 v112, v10, s13, v112
    v_lshlrev_b32 v12, 16, v82
    v_and_b32 v13, 0xffff0000, v82
    v_pk_mul_f32 v[12:13], v[12:13], v[8:9]
    v_cvt_pk_bf16_f32 v12, v12, v13
    v_dot2_f32_bf16 v114, v12, s13, v114
    v_lshlrev_b32 v8, 16, v27
    v_and_b32 v9, 0xffff0000, v27
    v_lshlrev_b32 v10, 16, v55
    v_and_b32 v11, 0xffff0000, v55
    v_pk_mul_f32 v[10:11], v[10:11], v[8:9]
    v_cvt_pk_bf16_f32 v10, v10, v11
    v_dot2_f32_bf16 v113, v10, s13, v113
    v_lshlrev_b32 v12, 16, v83
    v_and_b32 v13, 0xffff0000, v83
    v_pk_mul_f32 v[12:13], v[12:13], v[8:9]
    v_cvt_pk_bf16_f32 v12, v12, v13
    v_dot2_f32_bf16 v115, v12, s13, v115
    s_waitcnt vmcnt(18)
    v_lshlrev_b32 v8, 16, v28
    v_and_b32 v9, 0xffff0000, v28
    s_waitcnt vmcnt(17)
    v_lshlrev_b32 v10, 16, v56
    v_and_b32 v11, 0xffff0000, v56
    v_pk_mul_f32 v[10:11], v[10:11], v[8:9]
    v_cvt_pk_bf16_f32 v10, v10, v11
    v_dot2_f32_bf16 v112, v10, s13, v112
    s_waitcnt vmcnt(16)
    v_lshlrev_b32 v12, 16, v84
    v_and_b32 v13, 0xffff0000, v84
    v_pk_mul_f32 v[12:13], v[12:13], v[8:9]
    v_cvt_pk_bf16_f32 v12, v12, v13
    v_dot2_f32_bf16 v114, v12, s13, v114
    v_lshlrev_b32 v8, 16, v29
    v_and_b32 v9, 0xffff0000, v29
    v_lshlrev_b32 v10, 16, v57
    v_and_b32 v11, 0xffff0000, v57
    v_pk_mul_f32 v[10:11], v[10:11], v[8:9]
    v_cvt_pk_bf16_f32 v10, v10, v11
    v_dot2_f32_bf16 v113, v10, s13, v113
    v_lshlrev_b32 v12, 16, v85
    v_and_b32 v13, 0xffff0000, v85
    v_pk_mul_f32 v[12:13], v[12:13], v[8:9]
    v_cvt_pk_bf16_f32 v12, v12, v13
    v_dot2_f32_bf16 v115, v12, s13, v115
    v_lshlrev_b32 v8, 16, v30
    v_and_b32 v9, 0xffff0000, v30
    v_lshlrev_b32 v10, 16, v58
    v_and_b32 v11, 0xffff0000, v58
    v_pk_mul_f32 v[10:11], v[10:11], v[8:9]
    v_cvt_pk_bf16_f32 v10, v10, v11
    v_dot2_f32_bf16 v112, v10, s13, v112
    v_lshlrev_b32 v12, 16, v86
    v_and_b32 v13, 0xffff0000, v86
    v_pk_mul_f32 v[12:13], v[12:13], v[8:9]
    v_cvt_pk_bf16_f32 v12, v12, v13
    v_dot2_f32_bf16 v114, v12, s13, v114
    v_lshlrev_b32 v8, 16, v31
    v_and_b32 v9, 0xffff0000, v31
    v_lshlrev_b32 v10, 16, v59
    v_and_b32 v11, 0xffff0000, v59
    v_pk_mul_f32 v[10:11], v[10:11], v[8:9]
    v_cvt_pk_bf16_f32 v10, v10, v11
    v_dot2_f32_bf16 v113, v10, s13, v113
    v_lshlrev_b32 v12, 16, v87
    v_and_b32 v13, 0xffff0000, v87
    v_pk_mul_f32 v[12:13], v[12:13], v[8:9]
    v_cvt_pk_bf16_f32 v12, v12, v13
    v_dot2_f32_bf16 v115, v12, s13, v115
    s_waitcnt vmcnt(15)
    v_lshlrev_b32 v8, 16, v32
    v_and_b32 v9, 0xffff0000, v32
    s_waitcnt vmcnt(14)
    v_lshlrev_b32 v10, 16, v60
    v_and_b32 v11, 0xffff0000, v60
    v_pk_mul_f32 v[10:11], v[10:11], v[8:9]
    v_cvt_pk_bf16_f32 v10, v10, v11
    v_dot2_f32_bf16 v112, v10, s13, v112
    s_waitcnt vmcnt(13)
    v_lshlrev_b32 v12, 16, v88
    v_and_b32 v13, 0xffff0000, v88
    v_pk_mul_f32 v[12:13], v[12:13], v[8:9]
    v_cvt_pk_bf16_f32 v12, v12, v13
    v_dot2_f32_bf16 v114, v12, s13, v114
    v_lshlrev_b32 v8, 16, v33
    v_and_b32 v9, 0xffff0000, v33
    v_lshlrev_b32 v10, 16, v61
    v_and_b32 v11, 0xffff0000, v61
    v_pk_mul_f32 v[10:11], v[10:11], v[8:9]
    v_cvt_pk_bf16_f32 v10, v10, v11
    v_dot2_f32_bf16 v113, v10, s13, v113
    v_lshlrev_b32 v12, 16, v89
    v_and_b32 v13, 0xffff0000, v89
    v_pk_mul_f32 v[12:13], v[12:13], v[8:9]
    v_cvt_pk_bf16_f32 v12, v12, v13
    v_dot2_f32_bf16 v115, v12, s13, v115
    v_lshlrev_b32 v8, 16, v34
    v_and_b32 v9, 0xffff0000, v34
    v_lshlrev_b32 v10, 16, v62
    v_and_b32 v11, 0xffff0000, v62
    v_pk_mul_f32 v[10:11], v[10:11], v[8:9]
    v_cvt_pk_bf16_f32 v10, v10, v11
    v_dot2_f32_bf16 v112, v10, s13, v112
    v_lshlrev_b32 v12, 16, v90
    v_and_b32 v13, 0xffff0000, v90
    v_pk_mul_f32 v[12:13], v[12:13], v[8:9]
    v_cvt_pk_bf16_f32 v12, v12, v13
    v_dot2_f32_bf16 v114, v12, s13, v114
    v_lshlrev_b32 v8, 16, v35
    v_and_b32 v9, 0xffff0000, v35
    v_lshlrev_b32 v10, 16, v63
    v_and_b32 v11, 0xffff0000, v63
    v_pk_mul_f32 v[10:11], v[10:11], v[8:9]
    v_cvt_pk_bf16_f32 v10, v10, v11
    v_dot2_f32_bf16 v113, v10, s13, v113
    v_lshlrev_b32 v12, 16, v91
    v_and_b32 v13, 0xffff0000, v91
    v_pk_mul_f32 v[12:13], v[12:13], v[8:9]
    v_cvt_pk_bf16_f32 v12, v12, v13
    v_dot2_f32_bf16 v115, v12, s13, v115
    s_waitcnt vmcnt(12)
    v_lshlrev_b32 v8, 16, v36
    v_and_b32 v9, 0xffff0000, v36
    s_waitcnt vmcnt(11)
    v_lshlrev_b32 v10, 16, v64
    v_and_b32 v11, 0xffff0000, v64
    v_pk_mul_f32 v[10:11], v[10:11], v[8:9]
    v_cvt_pk_bf16_f32 v10, v10, v11
    v_dot2_f32_bf16 v112, v10, s13, v112
    s_waitcnt vmcnt(10)
    v_lshlrev_b32 v12, 16, v92
    v_and_b32 v13, 0xffff0000, v92
    v_pk_mul_f32 v[12:13], v[12:13], v[8:9]
    v_cvt_pk_bf16_f32 v12, v12, v13
    v_dot2_f32_bf16 v114, v12, s13, v114
    v_lshlrev_b32 v8, 16, v37
    v_and_b32 v9, 0xffff0000, v37
    v_lshlrev_b32 v10, 16, v65
    v_and_b32 v11, 0xffff0000, v65
    v_pk_mul_f32 v[10:11], v[10:11], v[8:9]
    v_cvt_pk_bf16_f32 v10, v10, v11
    v_dot2_f32_bf16 v113, v10, s13, v113
    v_lshlrev_b32 v12, 16, v93
    v_and_b32 v13, 0xffff0000, v93
    v_pk_mul_f32 v[12:13], v[12:13], v[8:9]
    v_cvt_pk_bf16_f32 v12, v12, v13
    v_dot2_f32_bf16 v115, v12, s13, v115
    v_lshlrev_b32 v8, 16, v38
    v_and_b32 v9, 0xffff0000, v38
    v_lshlrev_b32 v10, 16, v66
    v_and_b32 v11, 0xffff0000, v66
    v_pk_mul_f32 v[10:11], v[10:11], v[8:9]
    v_cvt_pk_bf16_f32 v10, v10, v11
    v_dot2_f32_bf16 v112, v10, s13, v112
    v_lshlrev_b32 v12, 16, v94
    v_and_b32 v13, 0xffff0000, v94
    v_pk_mul_f32 v[12:13], v[12:13], v[8:9]
    v_cvt_pk_bf16_f32 v12, v12, v13
    v_dot2_f32_bf16 v114, v12, s13, v114
    v_lshlrev_b32 v8, 16, v39
    v_and_b32 v9, 0xffff0000, v39
    v_lshlrev_b32 v10, 16, v67
    v_and_b32 v11, 0xffff0000, v67
    v_pk_mul_f32 v[10:11], v[10:11], v[8:9]
    v_cvt_pk_bf16_f32 v10, v10, v11
    v_dot2_f32_bf16 v113, v10, s13, v113
    v_lshlrev_b32 v12, 16, v95
    v_and_b32 v13, 0xffff0000, v95
    v_pk_mul_f32 v[12:13], v[12:13], v[8:9]
    v_cvt_pk_bf16_f32 v12, v12, v13
    v_dot2_f32_bf16 v115, v12, s13, v115
    s_waitcnt vmcnt(9)
    v_lshlrev_b32 v8, 16, v40
    v_and_b32 v9, 0xffff0000, v40
    s_waitcnt vmcnt(8)
    v_lshlrev_b32 v10, 16, v68
    v_and_b32 v11, 0xffff0000, v68
    v_pk_mul_f32 v[10:11], v[10:11], v[8:9]
    v_cvt_pk_bf16_f32 v10, v10, v11
    v_dot2_f32_bf16 v112, v10, s13, v112
    s_waitcnt vmcnt(7)
    v_lshlrev_b32 v12, 16, v96
    v_and_b32 v13, 0xffff0000, v96
    v_pk_mul_f32 v[12:13], v[12:13], v[8:9]
    v_cvt_pk_bf16_f32 v12, v12, v13
    v_dot2_f32_bf16 v114, v12, s13, v114
    v_lshlrev_b32 v8, 16, v41
    v_and_b32 v9, 0xffff0000, v41
    v_lshlrev_b32 v10, 16, v69
    v_and_b32 v11, 0xffff0000, v69
    v_pk_mul_f32 v[10:11], v[10:11], v[8:9]
    v_cvt_pk_bf16_f32 v10, v10, v11
    v_dot2_f32_bf16 v113, v10, s13, v113
    v_lshlrev_b32 v12, 16, v97
    v_and_b32 v13, 0xffff0000, v97
    v_pk_mul_f32 v[12:13], v[12:13], v[8:9]
    v_cvt_pk_bf16_f32 v12, v12, v13
    v_dot2_f32_bf16 v115, v12, s13, v115
    v_lshlrev_b32 v8, 16, v42
    v_and_b32 v9, 0xffff0000, v42
    v_lshlrev_b32 v10, 16, v70
    v_and_b32 v11, 0xffff0000, v70
    v_pk_mul_f32 v[10:11], v[10:11], v[8:9]
    v_cvt_pk_bf16_f32 v10, v10, v11
    v_dot2_f32_bf16 v112, v10, s13, v112
    v_lshlrev_b32 v12, 16, v98
    v_and_b32 v13, 0xffff0000, v98
    v_pk_mul_f32 v[12:13], v[12:13], v[8:9]
    v_cvt_pk_bf16_f32 v12, v12, v13
    v_dot2_f32_bf16 v114, v12, s13, v114
    v_lshlrev_b32 v8, 16, v43
    v_and_b32 v9, 0xffff0000, v43
    v_lshlrev_b32 v10, 16, v71
    v_and_b32 v11, 0xffff0000, v71
    v_pk_mul_f32 v[10:11], v[10:11], v[8:9]
    v_cvt_pk_bf16_f32 v10, v10, v11
    v_dot2_f32_bf16 v113, v10, s13, v113
    v_lshlrev_b32 v12, 16, v99
    v_and_b32 v13, 0xffff0000, v99
    v_pk_mul_f32 v[12:13], v[12:13], v[8:9]
    v_cvt_pk_bf16_f32 v12, v12, v13
    v_dot2_f32_bf16 v115, v12, s13, v115
    s_waitcnt vmcnt(6)
    v_lshlrev_b32 v8, 16, v44
    v_and_b32 v9, 0xffff0000, v44
    s_waitcnt vmcnt(5)
    v_lshlrev_b32 v10, 16, v72
    v_and_b32 v11, 0xffff0000, v72
    v_pk_mul_f32 v[10:11], v[10:11], v[8:9]
    v_cvt_pk_bf16_f32 v10, v10, v11
    v_dot2_f32_bf16 v112, v10, s13, v112
    s_waitcnt vmcnt(4)
    v_lshlrev_b32 v12, 16, v100
    v_and_b32 v13, 0xffff0000, v100
    v_pk_mul_f32 v[12:13], v[12:13], v[8:9]
    v_cvt_pk_bf16_f32 v12, v12, v13
    v_dot2_f32_bf16 v114, v12, s13, v114
    v_lshlrev_b32 v8, 16, v45
    v_and_b32 v9, 0xffff0000, v45
    v_lshlrev_b32 v10, 16, v73
    v_and_b32 v11, 0xffff0000, v73
    v_pk_mul_f32 v[10:11], v[10:11], v[8:9]
    v_cvt_pk_bf16_f32 v10, v10, v11
    v_dot2_f32_bf16 v113, v10, s13, v113
    v_lshlrev_b32 v12, 16, v101
    v_and_b32 v13, 0xffff0000, v101
    v_pk_mul_f32 v[12:13], v[12:13], v[8:9]
    v_cvt_pk_bf16_f32 v12, v12, v13
    v_dot2_f32_bf16 v115, v12, s13, v115
    v_lshlrev_b32 v8, 16, v46
    v_and_b32 v9, 0xffff0000, v46
    v_lshlrev_b32 v10, 16, v74
    v_and_b32 v11, 0xffff0000, v74
    v_pk_mul_f32 v[10:11], v[10:11], v[8:9]
    v_cvt_pk_bf16_f32 v10, v10, v11
    v_dot2_f32_bf16 v112, v10, s13, v112
    v_lshlrev_b32 v12, 16, v102
    v_and_b32 v13, 0xffff0000, v102
    v_pk_mul_f32 v[12:13], v[12:13], v[8:9]
    v_cvt_pk_bf16_f32 v12, v12, v13
    v_dot2_f32_bf16 v114, v12, s13, v114
    v_lshlrev_b32 v8, 16, v47
    v_and_b32 v9, 0xffff0000, v47
    v_lshlrev_b32 v10, 16, v75
    v_and_b32 v11, 0xffff0000, v75
    v_pk_mul_f32 v[10:11], v[10:11], v[8:9]
    v_cvt_pk_bf16_f32 v10, v10, v11
    v_dot2_f32_bf16 v113, v10, s13, v113
    v_lshlrev_b32 v12, 16, v103
    v_and_b32 v13, 0xffff0000, v103
    v_pk_mul_f32 v[12:13], v[12:13], v[8:9]
    v_cvt_pk_bf16_f32 v12, v12, v13
    v_dot2_f32_bf16 v115, v12, s13, v115
    s_nop 2
    s_waitcnt vmcnt(3)
    v_readfirstlane_b32 s50, v106
    s_nop 0
    s_lshr_b32 s83, s50, 3
    s_add_u32 s83, s83, 1
    s_lshl_b32 s83, s83, 3
    v_add_f32 v112, v112, v113
    s_nop 1
    v_add_f32_dpp v112, v112, v112 quad_perm:[1,0,3,2] row_mask:0xf bank_mask:0xf
    s_nop 1
    v_add_f32_dpp v112, v112, v112 quad_perm:[2,3,0,1] row_mask:0xf bank_mask:0xf
    s_nop 1
    v_add_f32_dpp v112, v112, v112 row_half_mirror row_mask:0xf bank_mask:0xf
    v_cvt_pk_bf16_f32 v112, 0, v112
    v_mul_f32 v112, 0xbfb8aa3b, v112
    v_exp_f32 v112, v112
    s_nop 0
    v_add_f32 v112, 1.0, v112
    v_rcp_f32 v112, v112
    s_nop 0
    v_cvt_pk_bf16_f32 v112, 0, v112
    v_mov_b32 v113, s83
    v_add_f32 v114, v114, v115
    s_nop 1
    v_add_f32_dpp v114, v114, v114 quad_perm:[1,0,3,2] row_mask:0xf bank_mask:0xf
    s_nop 1
    v_add_f32_dpp v114, v114, v114 quad_perm:[2,3,0,1] row_mask:0xf bank_mask:0xf
    s_nop 1
    v_add_f32_dpp v114, v114, v114 row_half_mirror row_mask:0xf bank_mask:0xf
    v_cvt_pk_bf16_f32 v114, 0, v114
    v_mul_f32 v114, 0xbfb8aa3b, v114
    v_exp_f32 v114, v114
    s_nop 0
    v_add_f32 v114, 1.0, v114
    v_rcp_f32 v114, v114
    s_nop 0
    v_cvt_pk_bf16_f32 v114, 0, v114
    v_mov_b32 v115, s83
    v_lshlrev_b32 v104, 3, v105
    v_add_u32 v104, 0xf00000, v104
    s_mov_b32 s10, 0x1010101
    s_mov_b32 s11, 0x1010101
    s_mov_b64 exec, s[10:11]
    buffer_store_dwordx2 v[112:113], v104, s[64:67], 0 offen sc1
    buffer_store_dwordx2 v[114:115], v104, s[64:67], 0 offen offset:64 sc1
    s_mov_b64 exec, -1
    s_cmp_ge_u32 s2, 14
    s_cbranch_scc1 L_HE
    s_waitcnt vmcnt(4)
    v_lshlrev_b32 v107, 16, v107
    s_waitcnt vmcnt(3)
    v_lshlrev_b32 v108, 16, v108
    s_waitcnt vmcnt(2)
    v_lshlrev_b32 v109, 16, v109
    v_mul_f32 v109, 0x3fb8aa3b, v109
    v_exp_f32 v109, v109
    s_nop 0
    v_cvt_pk_bf16_f32 v109, 0, v109
    v_mul_f32 v12, v109, v107
    v_mul_f32 v13, v109, v108
    v_mul_f32 v12, 0x3fb8aa3b, v12
    v_exp_f32 v12, v12
    v_mul_f32 v13, 0x3e22f983, v13
    v_rndne_f32 v14, v13
    v_sub_f32 v13, v13, v14
    v_cos_f32 v14, v13
    v_sin_f32 v15, v13
    v_mul_f32 v14, v12, v14
    v_mul_f32 v15, v12, v15
    v_mov_b32 v107, v14
    v_mov_b32 v108, v15
    v_mul_f32 v12, v108, v108
    v_mul_f32 v13, v107, v108
    v_fma_f32 v110, v107, v107, -v12
    v_add_f32 v111, v13, v13
    v_mul_f32 v12, v111, v111
    v_mul_f32 v13, v110, v111
    v_fma_f32 v110, v110, v110, -v12
    v_add_f32 v111, v13, v13
    v_mul_f32 v12, v111, v111
    v_mul_f32 v13, v110, v111
    v_fma_f32 v110, v110, v110, -v12
    v_add_f32 v111, v13, v13
    v_mul_f32 v12, v111, v111
    v_mul_f32 v13, v110, v111
    v_fma_f32 v110, v110, v110, -v12
    v_add_f32 v111, v13, v13
    v_mul_f32 v12, v111, v111
    v_mul_f32 v13, v110, v111
    v_fma_f32 v116, v110, v110, -v12
    v_add_f32 v117, v13, v13
    v_mul_f32 v12, v117, v117
    v_mul_f32 v13, v116, v117
    v_fma_f32 v118, v116, v116, -v12
    v_add_f32 v119, v13, v13
    v_mul_f32 v12, v119, v119
    v_mul_f32 v13, v118, v119
    v_fma_f32 v118, v118, v118, -v12
    v_add_f32 v119, v13, v13
    v_mul_f32 v12, v119, v119
    v_mul_f32 v13, v118, v119
    v_fma_f32 v118, v118, v118, -v12
    v_add_f32 v119, v13, v13
    v_lshrrev_b32 v120, 5, v0
    v_and_b32 v123, 31, v1
    s_lshl_b32 s9, s81, 15
    s_add_u32 s9, s9, 0xe00000
    v_lshlrev_b32 v121, 12, v120
    v_lshl_add_u32 v121, v123, 4, v121
    v_add_u32 v121, s9, v121
    v_lshlrev_b32 v122, 3, v0
    v_lshlrev_b32 v123, 3, v123
    buffer_load_dwordx4 v[48:51], v121, s[64:67], 0 offen sc1
    buffer_load_dwordx4 v[52:55], v121, s[64:67], 0 offen offset:512 sc1
    buffer_load_dwordx4 v[56:59], v121, s[64:67], 0 offen offset:1024 sc1
    buffer_load_dwordx4 v[60:63], v121, s[64:67], 0 offen offset:1536 sc1
    buffer_load_dwordx4 v[64:67], v121, s[64:67], 0 offen offset:2048 sc1
    buffer_load_dwordx4 v[68:71], v121, s[64:67], 0 offen offset:2560 sc1
    buffer_load_dwordx4 v[72:75], v121, s[64:67], 0 offen offset:3072 sc1
    buffer_load_dwordx4 v[76:79], v121, s[64:67], 0 offen offset:3584 sc1
    v_mov_b32 v8, s83
    v_mov_b32 v9, s83
    s_waitcnt vmcnt(7)
    v_min3_u32 v8, v49, v51, v8
    v_max3_u32 v9, v49, v51, v9
    s_waitcnt vmcnt(6)
    v_min3_u32 v8, v53, v55, v8
    v_max3_u32 v9, v53, v55, v9
    s_waitcnt vmcnt(5)
    v_min3_u32 v8, v57, v59, v8
    v_max3_u32 v9, v57, v59, v9
    s_waitcnt vmcnt(4)
    v_min3_u32 v8, v61, v63, v8
    v_max3_u32 v9, v61, v63, v9
    s_waitcnt vmcnt(3)
    v_min3_u32 v8, v65, v67, v8
    v_max3_u32 v9, v65, v67, v9
    s_waitcnt vmcnt(2)
    v_min3_u32 v8, v69, v71, v8
    v_max3_u32 v9, v69, v71, v9
    s_waitcnt vmcnt(1)
    v_min3_u32 v8, v73, v75, v8
    v_max3_u32 v9, v73, v75, v9
    s_waitcnt vmcnt(0)
    v_min3_u32 v8, v77, v79, v8
    v_max3_u32 v9, v77, v79, v9
    v_cmp_ne_u32 vcc, v8, v9
    s_nop 0
    s_cmp_lg_u64 vcc, 0
    s_cbranch_scc1 SPIN_17
RES_18:
    v_fma_f32 v8, v116, v48, v52
    v_fma_f32 v9, v116, v50, v54
    v_fma_f32 v8, -v117, v50, v8
    v_fmac_f32 v9, v117, v48
    v_fma_f32 v10, v116, v8, v56
    v_fma_f32 v11, v116, v9, v58
    v_fma_f32 v10, -v117, v9, v10
    v_fmac_f32 v11, v117, v8
    v_fma_f32 v8, v116, v10, v60
    v_fma_f32 v9, v116, v11, v62
    v_fma_f32 v8, -v117, v11, v8
    v_fmac_f32 v9, v117, v10
    v_fma_f32 v10, v116, v8, v64
    v_fma_f32 v11, v116, v9, v66
    v_fma_f32 v10, -v117, v9, v10
    v_fmac_f32 v11, v117, v8
    v_fma_f32 v8, v116, v10, v68
    v_fma_f32 v9, v116, v11, v70
    v_fma_f32 v8, -v117, v11, v8
    v_fmac_f32 v9, v117, v10
    v_fma_f32 v10, v116, v8, v72
    v_fma_f32 v11, v116, v9, v74
    v_fma_f32 v10, -v117, v9, v10
    v_fmac_f32 v11, v117, v8
    v_fma_f32 v8, v116, v10, v76
    v_fma_f32 v9, v116, v11, v78
    v_fma_f32 v8, -v117, v11, v8
    v_fmac_f32 v9, v117, v10
    ds_write_b64 v122, v[8:9]
    s_waitcnt lgkmcnt(0)
    s_barrier
    ds_read_b64 v[20:21], v123
    ds_read_b64 v[22:23], v123 offset:256
    ds_read_b64 v[24:25], v123 offset:512
    ds_read_b64 v[26:27], v123 offset:768
    ds_read_b64 v[28:29], v123 offset:1024
    ds_read_b64 v[30:31], v123 offset:1280
    ds_read_b64 v[32:33], v123 offset:1536
    ds_read_b64 v[34:35], v123 offset:1792
    v_mov_b32 v124, 0
    v_mov_b32 v125, 0
    v_cmp_eq_u32 vcc, 1, v120
    s_waitcnt lgkmcnt(6)
    v_fma_f32 v8, v118, v20, v22
    v_fma_f32 v9, v118, v21, v23
    v_fma_f32 v8, -v119, v21, v8
    v_fmac_f32 v9, v119, v20
    v_cndmask_b32 v124, v124, v20, vcc
    v_cndmask_b32 v125, v125, v21, vcc
    v_cmp_eq_u32 vcc, 2, v120
    s_waitcnt lgkmcnt(5)
    v_fma_f32 v10, v118, v8, v24
    v_fma_f32 v11, v118, v9, v25
    v_fma_f32 v10, -v119, v9, v10
    v_fmac_f32 v11, v119, v8
    v_cndmask_b32 v124, v124, v8, vcc
    v_cndmask_b32 v125, v125, v9, vcc
    v_cmp_eq_u32 vcc, 3, v120
    s_waitcnt lgkmcnt(4)
    v_fma_f32 v8, v118, v10, v26
    v_fma_f32 v9, v118, v11, v27
    v_fma_f32 v8, -v119, v11, v8
    v_fmac_f32 v9, v119, v10
    v_cndmask_b32 v124, v124, v10, vcc
    v_cndmask_b32 v125, v125, v11, vcc
    v_cmp_eq_u32 vcc, 4, v120
    s_waitcnt lgkmcnt(3)
    v_fma_f32 v10, v118, v8, v28
    v_fma_f32 v11, v118, v9, v29
    v_fma_f32 v10, -v119, v9, v10
    v_fmac_f32 v11, v119, v8
    v_cndmask_b32 v124, v124, v8, vcc
    v_cndmask_b32 v125, v125, v9, vcc
    v_cmp_eq_u32 vcc, 5, v120
    s_waitcnt lgkmcnt(2)
    v_fma_f32 v8, v118, v10, v30
    v_fma_f32 v9, v118, v11, v31
    v_fma_f32 v8, -v119, v11, v8
    v_fmac_f32 v9, v119, v10
    v_cndmask_b32 v124, v124, v10, vcc
    v_cndmask_b32 v125, v125, v11, vcc
    v_cmp_eq_u32 vcc, 6, v120
    s_waitcnt lgkmcnt(1)
    v_fma_f32 v10, v118, v8, v32
    v_fma_f32 v11, v118, v9, v33
    v_fma_f32 v10, -v119, v9, v10
    v_fmac_f32 v11, v119, v8
    v_cndmask_b32 v124, v124, v8, vcc
    v_cndmask_b32 v125, v125, v9, vcc
    v_cmp_eq_u32 vcc, 7, v120
    s_nop 1
    v_cndmask_b32 v124, v124, v10, vcc
    v_cndmask_b32 v125, v125, v11, vcc
    v_add_u32 v121, 0x80000, v121
    v_mov_b32 v81, s83
    v_mov_b32 v83, s83
    v_mov_b32 v85, s83
    v_mov_b32 v87, s83
    v_mov_b32 v80, v124
    v_mov_b32 v82, v125
    buffer_store_dwordx4 v[80:83], v121, s[64:67], 0 offen sc1
    v_fma_f32 v84, v116, v80, v48
    v_fma_f32 v86, v116, v82, v50
    v_fma_f32 v84, -v117, v82, v84
    v_fmac_f32 v86, v117, v80
    buffer_store_dwordx4 v[84:87], v121, s[64:67], 0 offen offset:512 sc1
    v_fma_f32 v80, v116, v84, v52
    v_fma_f32 v82, v116, v86, v54
    v_fma_f32 v80, -v117, v86, v80
    v_fmac_f32 v82, v117, v84
    buffer_store_dwordx4 v[80:83], v121, s[64:67], 0 offen offset:1024 sc1
    v_fma_f32 v84, v116, v80, v56
    v_fma_f32 v86, v116, v82, v58
    v_fma_f32 v84, -v117, v82, v84
    v_fmac_f32 v86, v117, v80
    buffer_store_dwordx4 v[84:87], v121, s[64:67], 0 offen offset:1536 sc1
    v_fma_f32 v80, v116, v84, v60
    v_fma_f32 v82, v116, v86, v62
    v_fma_f32 v80, -v117, v86, v80
    v_fmac_f32 v82, v117, v84
    buffer_store_dwordx4 v[80:83], v121, s[64:67], 0 offen offset:2048 sc1
    v_fma_f32 v84, v116, v80, v64
    v_fma_f32 v86, v116, v82, v66
    v_fma_f32 v84, -v117, v82, v84
    v_fmac_f32 v86, v117, v80
    buffer_store_dwordx4 v[84:87], v121, s[64:67], 0 offen offset:2560 sc1
    v_fma_f32 v80, v116, v84, v68
    v_fma_f32 v82, v116, v86, v70
    v_fma_f32 v80, -v117, v86, v80
    v_fmac_f32 v82, v117, v84
    buffer_store_dwordx4 v[80:83], v121, s[64:67], 0 offen offset:3072 sc1
    v_fma_f32 v84, v116, v80, v72
    v_fma_f32 v86, v116, v82, v74
    v_fma_f32 v84, -v117, v82, v84
    v_fmac_f32 v86, v117, v80
    buffer_store_dwordx4 v[84:87], v121, s[64:67], 0 offen offset:3584 sc1
L_HE:
    s_mov_b32 s9, s86
    s_mov_b32 s10, s87
    s_mov_b32 s88, s40
    s_mov_b32 s89, s41
    s_mov_b32 s90, 0x188000
    s_mov_b32 s91, 0x20000
    s_cmp_eq_u32 s10, 1
    s_cselect_b32 s68, s28, s26
    s_cselect_b32 s69, s29, s27
    s_mov_b32 s70, 0x62000
    s_mov_b32 s71, 0x20000
    s_lshl_b32 s11, s9, 1
    s_add_u32 s11, s11, s10
    s_lshl_b32 s11, s11, 2
    s_add_u32 s11, s11, s3
    s_mul_i32 s11, s11, 0x7000
    v_add_u32 v76, s11, v2
    s_mul_i32 s11, s3, 0x70
    v_lshrrev_b32 v77, 3, v1
    v_add_u32 v77, s11, v77
    v_mul_u32_u24 v77, 0x380, v77
    v_and_b32 v8, 7, v1
    v_lshl_add_u32 v77, v8, 4, v77
    s_lshl_b32 s11, s9, 7
    v_add_u32 v77, s11, v77
    s_movk_i32 s98, 0
    buffer_load_dwordx4 v[20:23], v76, s[88:91], s98 offen
    s_movk_i32 s98, 0x400
    buffer_load_dwordx4 v[24:27], v76, s[88:91], s98 offen
    s_mov_b32 s98, 0
    buffer_load_dwordx4 v[28:31], v77, s[68:71], s98 offen
    s_movk_i32 s98, 0x800
    buffer_load_dwordx4 v[32:35], v76, s[88:91], s98 offen
    s_movk_i32 s98, 0xc00
    buffer_load_dwordx4 v[36:39], v76, s[88:91], s98 offen
    s_mov_b32 s98, 0x1c00
    buffer_load_dwordx4 v[40:43], v77, s[68:71], s98 offen
    s_movk_i32 s98, 0x1000
    buffer_load_dwordx4 v[44:47], v76, s[88:91], s98 offen
    s_movk_i32 s98, 0x1400
    buffer_load_dwordx4 v[48:51], v76, s[88:91], s98 offen
    s_mov_b32 s98, 0x3800
    buffer_load_dwordx4 v[52:55], v77, s[68:71], s98 offen
    s_movk_i32 s98, 0x1800
    buffer_load_dwordx4 v[56:59], v76, s[88:91], s98 offen
    s_movk_i32 s98, 0x1c00
    buffer_load_dwordx4 v[60:63], v76, s[88:91], s98 offen
    s_mov_b32 s98, 0x5400
    buffer_load_dwordx4 v[64:67], v77, s[68:71], s98 offen
    s_movk_i32 s98, 0x2000
    buffer_load_dwordx4 v[68:71], v76, s[88:91], s98 offen
    s_movk_i32 s98, 0x2400
    buffer_load_dwordx4 v[72:75], v76, s[88:91], s98 offen
    s_mov_b32 s98, 0x7000
    s_waitcnt vmcnt(13)
    buffer_load_dwordx4 v[20:23], v77, s[68:71], s98 offen
    s_movk_i32 s98, 0x2800
    s_waitcnt vmcnt(13)
    buffer_load_dwordx4 v[24:27], v76, s[88:91], s98 offen
    s_movk_i32 s98, 0x2c00
    s_waitcnt vmcnt(13)
    buffer_load_dwordx4 v[28:31], v76, s[88:91], s98 offen
    s_mov_b32 s98, 0x8c00
    s_waitcnt vmcnt(13)
    buffer_load_dwordx4 v[32:35], v77, s[68:71], s98 offen
    s_movk_i32 s98, 0x3000
    s_waitcnt vmcnt(13)
    buffer_load_dwordx4 v[36:39], v76, s[88:91], s98 offen
    s_movk_i32 s98, 0x3400
    s_waitcnt vmcnt(13)
    buffer_load_dwordx4 v[40:43], v76, s[88:91], s98 offen
    s_mov_b32 s98, 0xa800
    s_waitcnt vmcnt(13)
    buffer_load_dwordx4 v[44:47], v77, s[68:71], s98 offen
    s_movk_i32 s98, 0x3800
    s_waitcnt vmcnt(13)
    buffer_load_dwordx4 v[48:51], v76, s[88:91], s98 offen
    s_movk_i32 s98, 0x3c00
    s_waitcnt vmcnt(13)
    buffer_load_dwordx4 v[52:55], v76, s[88:91], s98 offen
    s_mov_b32 s98, 0xc400
    s_waitcnt vmcnt(13)
    buffer_load_dwordx4 v[56:59], v77, s[68:71], s98 offen
    s_movk_i32 s98, 0x4000
    s_waitcnt vmcnt(13)
    buffer_load_dwordx4 v[60:63], v76, s[88:91], s98 offen
    s_movk_i32 s98, 0x4400
    s_waitcnt vmcnt(13)
    buffer_load_dwordx4 v[64:67], v76, s[88:91], s98 offen
    s_mov_b32 s98, 0xe000
    s_waitcnt vmcnt(13)
    buffer_load_dwordx4 v[68:71], v77, s[68:71], s98 offen
    s_movk_i32 s98, 0x4800
    s_waitcnt vmcnt(13)
    buffer_load_dwordx4 v[72:75], v76, s[88:91], s98 offen
    s_movk_i32 s98, 0x4c00
    s_waitcnt vmcnt(13)
    buffer_load_dwordx4 v[20:23], v76, s[88:91], s98 offen
    s_mov_b32 s98, 0xfc00
    s_waitcnt vmcnt(13)
    buffer_load_dwordx4 v[24:27], v77, s[68:71], s98 offen
    s_movk_i32 s98, 0x5000
    s_waitcnt vmcnt(13)
    buffer_load_dwordx4 v[28:31], v76, s[88:91], s98 offen
    s_movk_i32 s98, 0x5400
    s_waitcnt vmcnt(13)
    buffer_load_dwordx4 v[32:35], v76, s[88:91], s98 offen
    s_mov_b32 s98, 0x11800
    s_waitcnt vmcnt(13)
    buffer_load_dwordx4 v[36:39], v77, s[68:71], s98 offen
    s_movk_i32 s98, 0x5800
    s_waitcnt vmcnt(13)
    buffer_load_dwordx4 v[40:43], v76, s[88:91], s98 offen
    s_movk_i32 s98, 0x5c00
    s_waitcnt vmcnt(13)
    buffer_load_dwordx4 v[44:47], v76, s[88:91], s98 offen
    s_mov_b32 s98, 0x13400
    s_waitcnt vmcnt(13)
    buffer_load_dwordx4 v[48:51], v77, s[68:71], s98 offen
    s_movk_i32 s98, 0x6000
    s_waitcnt vmcnt(13)
    buffer_load_dwordx4 v[52:55], v76, s[88:91], s98 offen
    s_movk_i32 s98, 0x6400
    s_waitcnt vmcnt(13)
    buffer_load_dwordx4 v[56:59], v76, s[88:91], s98 offen
    s_mov_b32 s98, 0x15000
    s_waitcnt vmcnt(13)
    buffer_load_dwordx4 v[60:63], v77, s[68:71], s98 offen
    s_movk_i32 s98, 0x6800
    s_waitcnt vmcnt(13)
    buffer_load_dwordx4 v[64:67], v76, s[88:91], s98 offen
    s_movk_i32 s98, 0x6c00
    s_waitcnt vmcnt(13)
    buffer_load_dwordx4 v[68:71], v76, s[88:91], s98 offen
    s_mov_b32 s98, 0x16c00
    s_waitcnt vmcnt(13)
    buffer_load_dwordx4 v[72:75], v77, s[68:71], s98 offen
    s_waitcnt vmcnt(0) lgkmcnt(0)
    s_cmp_lg_u32 s2, 31
    s_cbranch_scc1 L_END
    s_cmp_lg_u32 s3, 0
    s_cbranch_scc1 L_END
    v_lshlrev_b32 v38, 9, v1
    v_add_u32 v38, 0xe00004, v38
    v_lshlrev_b32 v39, 7, v1
    v_add_u32 v39, 0xf00000, v39
    s_movk_i32 s98, 0x2000
    s_mov_b32 s100, 0
    s_waitcnt vmcnt(0) lgkmcnt(0)
EP_LOOP:
    s_sleep 64
    s_mov_b32 s9, 0
    buffer_load_dword v20, v38, s[64:67], s9 offen sc1
    s_mov_b32 s9, 0x8000
    buffer_load_dword v21, v38, s[64:67], s9 offen sc1
    s_mov_b32 s9, 0x10000
    buffer_load_dword v22, v38, s[64:67], s9 offen sc1
    s_mov_b32 s9, 0x18000
    buffer_load_dword v23, v38, s[64:67], s9 offen sc1
    s_mov_b32 s9, 0x20000
    buffer_load_dword v24, v38, s[64:67], s9 offen sc1
    s_mov_b32 s9, 0x28000
    buffer_load_dword v25, v38, s[64:67], s9 offen sc1
    s_mov_b32 s9, 0x30000
    buffer_load_dword v26, v38, s[64:67], s9 offen sc1
    s_mov_b32 s9, 0x38000
    buffer_load_dword v27, v38, s[64:67], s9 offen sc1
    s_mov_b32 s9, 0x40000
    buffer_load_dword v28, v38, s[64:67], s9 offen sc1
    s_mov_b32 s9, 0x48000
    buffer_load_dword v29, v38, s[64:67], s9 offen sc1
    s_mov_b32 s9, 0x50000
    buffer_load_dword v30, v38, s[64:67], s9 offen sc1
    s_mov_b32 s9, 0x58000
    buffer_load_dword v31, v38, s[64:67], s9 offen sc1
    s_mov_b32 s9, 0x60000
    buffer_load_dword v32, v38, s[64:67], s9 offen sc1
    s_mov_b32 s9, 0x68000
    buffer_load_dword v33, v38, s[64:67], s9 offen sc1
    buffer_load_dwordx2 v[34:35], v39, s[64:67], 0 offen sc1
    buffer_load_dwordx2 v[36:37], v39, s[64:67], s98 offen sc1
    s_waitcnt vmcnt(0) lgkmcnt(0)
    s_mov_b64 s[14:15], 0
    v_cmp_ne_u32 vcc, s83, v20
    s_nop 0
    s_or_b64 s[14:15], s[14:15], vcc
    v_cmp_ne_u32 vcc, s83, v21
    s_nop 0
    s_or_b64 s[14:15], s[14:15], vcc
    v_cmp_ne_u32 vcc, s83, v22
    s_nop 0
    s_or_b64 s[14:15], s[14:15], vcc
    v_cmp_ne_u32 vcc, s83, v23
    s_nop 0
    s_or_b64 s[14:15], s[14:15], vcc
    v_cmp_ne_u32 vcc, s83, v24
    s_nop 0
    s_or_b64 s[14:15], s[14:15], vcc
    v_cmp_ne_u32 vcc, s83, v25
    s_nop 0
    s_or_b64 s[14:15], s[14:15], vcc
    v_cmp_ne_u32 vcc, s83, v26
    s_nop 0
    s_or_b64 s[14:15], s[14:15], vcc
    v_cmp_ne_u32 vcc, s83, v27
    s_nop 0
    s_or_b64 s[14:15], s[14:15], vcc
    v_cmp_ne_u32 vcc, s83, v28
    s_nop 0
    s_or_b64 s[14:15], s[14:15], vcc
    v_cmp_ne_u32 vcc, s83, v29
    s_nop 0
    s_or_b64 s[14:15], s[14:15], vcc
    v_cmp_ne_u32 vcc, s83, v30
    s_nop 0
    s_or_b64 s[14:15], s[14:15], vcc
    v_cmp_ne_u32 vcc, s83, v31
    s_nop 0
    s_or_b64 s[14:15], s[14:15], vcc
    v_cmp_ne_u32 vcc, s83, v32
    s_nop 0
    s_or_b64 s[14:15], s[14:15], vcc
    v_cmp_ne_u32 vcc, s83, v33
    s_nop 0
    s_or_b64 s[14:15], s[14:15], vcc
    v_cmp_ne_u32 vcc, s83, v35
    s_nop 0
    s_or_b64 s[14:15], s[14:15], vcc
    v_cmp_ne_u32 vcc, s83, v37
    s_nop 0
    s_or_b64 s[14:15], s[14:15], vcc
    s_cbranch_scc0 EP_DONE
    s_add_u32 s100, s100, 1
    s_cmp_lt_u32 s100, 0x40000
    s_cbranch_scc1 EP_LOOP
EP_DONE:
    v_mov_b32 v8, s83
    v_mov_b32 v9, 0xf08000
    s_mov_b64 exec, 1
    buffer_store_dword v8, v9, s[64:67], 0 offen sc1
L_END:
    s_endpgm
SPIN_1:
    s_mov_b32 s100, 0
SPIN_1_l:
    s_sleep 2
    s_nop 3
    buffer_load_dwordx2 v[228:229], v225, s[64:67], 0 offen sc1
    buffer_load_dwordx2 v[230:231], v226, s[64:67], 0 offen sc1
    s_waitcnt vmcnt(0) lgkmcnt(0)
    v_cmp_ne_u32 vcc, s83, v229
    v_cmp_ne_u32 s[12:13], s83, v231
    s_nop 0
    s_or_b64 vcc, vcc, s[12:13]
    s_nop 0
    s_cmp_lg_u64 vcc, 0
    s_cbranch_scc0 RES_2_x
    s_add_u32 s100, s100, 1
    s_cmp_lt_u32 s100, 0x40000
    s_cbranch_scc1 SPIN_1_l
RES_2_x:
    s_nop 4
    s_branch RES_2
SPIN_3:
    s_mov_b32 s100, 0
SPIN_3_l:
    s_sleep 2
    s_nop 3
    buffer_load_dwordx4 v[232:235], v227, s[64:67], 0 offen sc1
    s_waitcnt vmcnt(0) lgkmcnt(0)
    v_cmp_ne_u32 vcc, s83, v233
    v_cmp_ne_u32 s[12:13], s83, v235
    s_nop 0
    s_or_b64 vcc, vcc, s[12:13]
    s_nop 0
    s_cmp_lg_u64 vcc, 0
    s_cbranch_scc0 RES_4_x
    s_add_u32 s100, s100, 1
    s_cmp_lt_u32 s100, 0x40000
    s_cbranch_scc1 SPIN_3_l
RES_4_x:
    s_nop 4
    s_branch RES_4
SPIN_5:
    s_mov_b32 s100, 0
SPIN_5_l:
    s_sleep 2
    s_nop 3
    s_lshl_b32 s99, s93, 6
    buffer_load_dwordx4 v[60:63], v240, s[64:67], s99 offen sc1
    buffer_load_dwordx4 v[64:67], v240, s[64:67], s99 offen offset:1024 sc1
    s_waitcnt vmcnt(0) lgkmcnt(0)
    v_xor_b32 v60, v60, v4
    v_xor_b32 v61, v61, v5
    v_or_b32 v11, v60, v61
    v_xor_b32 v62, v62, v6
    v_xor_b32 v63, v63, v7
    v_or3_b32 v11, v62, v63, v11
    v_xor_b32 v64, v64, v4
    v_xor_b32 v65, v65, v5
    v_or3_b32 v11, v64, v65, v11
    v_xor_b32 v66, v66, v6
    v_xor_b32 v67, v67, v7
    v_or3_b32 v11, v66, v67, v11
    v_and_b32 v11, 1, v11
    v_cmp_ne_u32 vcc, 0, v11
    s_nop 0
    s_cmp_lg_u64 vcc, 0
    s_cbranch_scc0 RES_6_x
    s_add_u32 s100, s100, 1
    s_cmp_lt_u32 s100, 0x40000
    s_cbranch_scc1 SPIN_5_l
RES_6_x:
    s_nop 4
    s_branch RES_6
SPIN_7:
    s_mov_b32 s100, 0
SPIN_7_l:
    s_sleep 2
    s_nop 3
    s_lshl_b32 s99, s94, 6
    buffer_load_dwordx4 v[68:71], v240, s[64:67], s99 offen sc1
    buffer_load_dwordx4 v[72:75], v240, s[64:67], s99 offen offset:1024 sc1
    s_waitcnt vmcnt(0) lgkmcnt(0)
    v_xor_b32 v68, v68, v4
    v_xor_b32 v69, v69, v5
    v_or_b32 v11, v68, v69
    v_xor_b32 v70, v70, v6
    v_xor_b32 v71, v71, v7
    v_or3_b32 v11, v70, v71, v11
    v_xor_b32 v72, v72, v4
    v_xor_b32 v73, v73, v5
    v_or3_b32 v11, v72, v73, v11
    v_xor_b32 v74, v74, v6
    v_xor_b32 v75, v75, v7
    v_or3_b32 v11, v74, v75, v11
    v_and_b32 v11, 1, v11
    v_cmp_ne_u32 vcc, 0, v11
    s_nop 0
    s_cmp_lg_u64 vcc, 0
    s_cbranch_scc0 RES_8_x
    s_add_u32 s100, s100, 1
    s_cmp_lt_u32 s100, 0x40000
    s_cbranch_scc1 SPIN_7_l
RES_8_x:
    s_nop 4
    s_branch RES_8
SPIN_9:
    s_mov_b32 s100, 0
SPIN_9_l:
    s_sleep 2
    s_nop 3
    s_lshl_b32 s99, s95, 6
    buffer_load_dwordx4 v[76:79], v240, s[64:67], s99 offen sc1
    buffer_load_dwordx4 v[80:83], v240, s[64:67], s99 offen offset:1024 sc1
    s_waitcnt vmcnt(0) lgkmcnt(0)
    v_xor_b32 v76, v76, v4
    v_xor_b32 v77, v77, v5
    v_or_b32 v11, v76, v77
    v_xor_b32 v78, v78, v6
    v_xor_b32 v79, v79, v7
    v_or3_b32 v11, v78, v79, v11
    v_xor_b32 v80, v80, v4
    v_xor_b32 v81, v81, v5
    v_or3_b32 v11, v80, v81, v11
    v_xor_b32 v82, v82, v6
    v_xor_b32 v83, v83, v7
    v_or3_b32 v11, v82, v83, v11
    v_and_b32 v11, 1, v11
    v_cmp_ne_u32 vcc, 0, v11
    s_nop 0
    s_cmp_lg_u64 vcc, 0
    s_cbranch_scc0 RES_10_x
    s_add_u32 s100, s100, 1
    s_cmp_lt_u32 s100, 0x40000
    s_cbranch_scc1 SPIN_9_l
RES_10_x:
    s_nop 4
    s_branch RES_10
SPIN_11:
    s_mov_b32 s100, 0
SPIN_11_l:
    s_sleep 2
    s_nop 3
    s_lshl_b32 s99, s96, 6
    buffer_load_dwordx4 v[84:87], v240, s[64:67], s99 offen sc1
    buffer_load_dwordx4 v[88:91], v240, s[64:67], s99 offen offset:1024 sc1
    s_waitcnt vmcnt(0) lgkmcnt(0)
    v_xor_b32 v84, v84, v4
    v_xor_b32 v85, v85, v5
    v_or_b32 v11, v84, v85
    v_xor_b32 v86, v86, v6
    v_xor_b32 v87, v87, v7
    v_or3_b32 v11, v86, v87, v11
    v_xor_b32 v88, v88, v4
    v_xor_b32 v89, v89, v5
    v_or3_b32 v11, v88, v89, v11
    v_xor_b32 v90, v90, v6
    v_xor_b32 v91, v91, v7
    v_or3_b32 v11, v90, v91, v11
    v_and_b32 v11, 1, v11
    v_cmp_ne_u32 vcc, 0, v11
    s_nop 0
    s_cmp_lg_u64 vcc, 0
    s_cbranch_scc0 RES_12_x
    s_add_u32 s100, s100, 1
    s_cmp_lt_u32 s100, 0x40000
    s_cbranch_scc1 SPIN_11_l
RES_12_x:
    s_nop 4
    s_branch RES_12
SPIN_13:
    s_mov_b32 s100, 0
SPIN_13_l:
    s_sleep 2
    s_nop 3
    s_lshl_b32 s99, s97, 6
    buffer_load_dwordx4 v[156:159], v240, s[64:67], s99 offen sc1
    buffer_load_dwordx4 v[160:163], v240, s[64:67], s99 offen offset:1024 sc1
    s_waitcnt vmcnt(0) lgkmcnt(0)
    v_xor_b32 v156, v156, v4
    v_xor_b32 v157, v157, v5
    v_or_b32 v11, v156, v157
    v_xor_b32 v158, v158, v6
    v_xor_b32 v159, v159, v7
    v_or3_b32 v11, v158, v159, v11
    v_xor_b32 v160, v160, v4
    v_xor_b32 v161, v161, v5
    v_or3_b32 v11, v160, v161, v11
    v_xor_b32 v162, v162, v6
    v_xor_b32 v163, v163, v7
    v_or3_b32 v11, v162, v163, v11
    v_and_b32 v11, 1, v11
    v_cmp_ne_u32 vcc, 0, v11
    s_nop 0
    s_cmp_lg_u64 vcc, 0
    s_cbranch_scc0 RES_14_x
    s_add_u32 s100, s100, 1
    s_cmp_lt_u32 s100, 0x40000
    s_cbranch_scc1 SPIN_13_l
RES_14_x:
    s_nop 4
    s_branch RES_14
SPIN_15:
    s_mov_b32 s100, 0
SPIN_15_l:
    s_sleep 2
    s_nop 3
    s_lshl_b32 s99, s86, 6
    buffer_load_dwordx4 v[164:167], v240, s[64:67], s99 offen sc1
    buffer_load_dwordx4 v[168:171], v240, s[64:67], s99 offen offset:1024 sc1
    s_waitcnt vmcnt(0) lgkmcnt(0)
    v_xor_b32 v164, v164, v4
    v_xor_b32 v165, v165, v5
    v_or_b32 v11, v164, v165
    v_xor_b32 v166, v166, v6
    v_xor_b32 v167, v167, v7
    v_or3_b32 v11, v166, v167, v11
    v_xor_b32 v168, v168, v4
    v_xor_b32 v169, v169, v5
    v_or3_b32 v11, v168, v169, v11
    v_xor_b32 v170, v170, v6
    v_xor_b32 v171, v171, v7
    v_or3_b32 v11, v170, v171, v11
    v_and_b32 v11, 1, v11
    v_cmp_ne_u32 vcc, 0, v11
    s_nop 0
    s_cmp_lg_u64 vcc, 0
    s_cbranch_scc0 RES_16_x
    s_add_u32 s100, s100, 1
    s_cmp_lt_u32 s100, 0x40000
    s_cbranch_scc1 SPIN_15_l
RES_16_x:
    s_nop 4
    s_branch RES_16
SPIN_17:
    s_mov_b32 s100, 0
SPIN_17_l:
    s_sleep 2
    s_nop 3
    buffer_load_dwordx4 v[48:51], v121, s[64:67], 0 offen sc1
    buffer_load_dwordx4 v[52:55], v121, s[64:67], 0 offen offset:512 sc1
    buffer_load_dwordx4 v[56:59], v121, s[64:67], 0 offen offset:1024 sc1
    buffer_load_dwordx4 v[60:63], v121, s[64:67], 0 offen offset:1536 sc1
    buffer_load_dwordx4 v[64:67], v121, s[64:67], 0 offen offset:2048 sc1
    buffer_load_dwordx4 v[68:71], v121, s[64:67], 0 offen offset:2560 sc1
    buffer_load_dwordx4 v[72:75], v121, s[64:67], 0 offen offset:3072 sc1
    buffer_load_dwordx4 v[76:79], v121, s[64:67], 0 offen offset:3584 sc1
    s_waitcnt vmcnt(0) lgkmcnt(0)
    v_mov_b32 v8, s83
    v_mov_b32 v9, s83
    v_min3_u32 v8, v49, v51, v8
    v_max3_u32 v9, v49, v51, v9
    v_min3_u32 v8, v53, v55, v8
    v_max3_u32 v9, v53, v55, v9
    v_min3_u32 v8, v57, v59, v8
    v_max3_u32 v9, v57, v59, v9
    v_min3_u32 v8, v61, v63, v8
    v_max3_u32 v9, v61, v63, v9
    v_min3_u32 v8, v65, v67, v8
    v_max3_u32 v9, v65, v67, v9
    v_min3_u32 v8, v69, v71, v8
    v_max3_u32 v9, v69, v71, v9
    v_min3_u32 v8, v73, v75, v8
    v_max3_u32 v9, v73, v75, v9
    v_min3_u32 v8, v77, v79, v8
    v_max3_u32 v9, v77, v79, v9
    v_cmp_ne_u32 vcc, v8, v9
    s_nop 0
    s_cmp_lg_u64 vcc, 0
    s_cbranch_scc0 RES_18_x
    s_add_u32 s100, s100, 1
    s_cmp_lt_u32 s100, 0x40000
    s_cbranch_scc1 SPIN_17_l
RES_18_x:
    s_nop 4
    s_branch RES_18
    s_endpgm
.if (. - PCBASE) < 33024
.fill (33024 - (. - PCBASE)) / 4 + 1, 4, 0xBF810000
.endif

.section .rodata,"a"
.p2align 6
.amdhsa_kernel gated_mix__ssm_conv_s5__glu_gated_swiglu__prompt_kernel
  .amdhsa_next_free_vgpr 512
  .amdhsa_next_free_sgpr 102
  .amdhsa_accum_offset 256
  .amdhsa_group_segment_fixed_size 0
  .amdhsa_kernarg_size 136
  .amdhsa_user_sgpr_count 2
  .amdhsa_user_sgpr_kernarg_segment_ptr 1
  .amdhsa_system_sgpr_workgroup_id_x 1
  .amdhsa_float_denorm_mode_32 3
.end_amdhsa_kernel
```
